```python
import torch

def _softmax(x, axis=-1):
    return torch.softmax(x, dim=axis)
def _gelu(x):
    return torch.nn.functional.gelu(x, approximate="tanh")
def _silu(x):
    return torch.nn.functional.silu(x)
def _sigmoid(x):
    return torch.sigmoid(x)
def _layernorm(x, axis=-1, eps=1e-5):
    m = x.mean(dim=axis, keepdim=True)
    v = x.var(dim=axis, keepdim=True, unbiased=False)
    return (x - m) / torch.sqrt(v + eps)
def _scatter_add(tgt, idx, src, axis=0):
    return tgt.clone().index_add_(axis, idx, src)
def _segment_sum(src, seg, n):
    out = torch.zeros((n,) + src.shape[1:], dtype=src.dtype)
    return out.index_add_(0, seg, src)
def _pad(x, pw):
    flat = tuple(v for pair in reversed(pw) for v in pair)
    return torch.nn.functional.pad(x, flat)

kernel_name = 'parallel_sum__sliding_block_cached__mixer_channel_mlp__decode'

def setup_inputs():

    _w = (lambda a: (lambda t: t.to(torch.bfloat16) if t.is_floating_point() else t)(torch.as_tensor(a)))
    def _A_setup():
        B, Sq, D = 1, 1, 512
        Hq, Hkv, Sk, Dh = 32, 32, 16384, 128
        assert Hq % Hkv == 0, (Hq, Hkv)
        return {
            "x": _w((lambda *s: torch.randn(*s, dtype=torch.bfloat16) * 0.05)(B, Sq, D)),
            "k_cache": _w((lambda *s: torch.randn(*s, dtype=torch.bfloat16) * 3.2)(B, Hkv, Sk, Dh)),
            "v_cache": _w((lambda *s: torch.randn(*s, dtype=torch.bfloat16) * 0.4)(B, Hkv, Sk, Dh)),
            "wq": _w((lambda *s: torch.randn(*s, dtype=torch.bfloat16) * 3.2)(D, Hq * Dh) * (D ** -0.5)),
            "wo": _w((lambda *s: torch.randn(*s, dtype=torch.bfloat16) * 0.4)(Hq * Dh, D) * ((Hq * Dh) ** -0.5)),
        }
    _A_in = _A_setup()

    def _B_setup():
        B, S, D, F = 1, 1, 512, 1376
        return {
            "x": _w((lambda *s: torch.randn(*s, dtype=torch.bfloat16) * 0.05)(B, S, D)),
            "w1": _w((lambda *s: torch.randn(*s, dtype=torch.bfloat16) * 1.6)(D, F) * (D ** -0.5)),
            "b1": _w((lambda *s: torch.randn(*s, dtype=torch.bfloat16) * 1.6)(F)),
            "w2": _w((lambda *s: torch.randn(*s, dtype=torch.bfloat16) * 0.1)(F, D) * (F ** -0.5)),
            "b2": _w((lambda *s: torch.randn(*s, dtype=torch.bfloat16) * 0.1)(D)),
        }
    _B_in = _B_setup()

    return {
        "A_x": _A_in["x"],
        "A_k_cache": _A_in["k_cache"],
        "A_v_cache": _A_in["v_cache"],
        "A_wq": _A_in["wq"],
        "A_wo": _A_in["wo"],
        "B_x": _B_in["x"],
        "B_w1": _B_in["w1"],
        "B_b1": _B_in["b1"],
        "B_w2": _B_in["w2"],
        "B_b2": _B_in["b2"],
    }

def reference(A_x, A_k_cache, A_v_cache, A_wq, A_wo, B_x, B_w1, B_b1, B_w2, B_b2):
    def _A_ref(x, k_cache, v_cache, wq, wo):
        B, Sq, D = x.shape
        Hq, Dh = 32, 128
        Hkv, Sk = k_cache.shape[1], k_cache.shape[2]
        W = min(4096, max(256, Sk // 4))
        rep = Hq // Hkv
        q = (lambda x, *d: x.permute(*d))((x @ wq).reshape(B, Sq, Hq, Dh), 0, 2, 1, 3)
        k = (lambda x, n, axis: torch.repeat_interleave(x, n, dim=axis))(k_cache[:, :, Sk - W:, :], rep, axis=1)
        v = (lambda x, n, axis: torch.repeat_interleave(x, n, dim=axis))(v_cache[:, :, Sk - W:, :], rep, axis=1)
        scores = torch.einsum("bhqd,bhkd->bhqk", q, k) * (Dh ** -0.5)
        p = _softmax(scores, axis=-1)
        o = torch.einsum("bhqk,bhkd->bhqd", p, v)
        return (lambda x, *d: x.permute(*d))(o, 0, 2, 1, 3).reshape(B, Sq, Hq * Dh) @ wo

    def _B_ref(x, w1, b1, w2, b2):
        y = _layernorm(x, axis=-1)
        h = _gelu(torch.einsum("bsd,df->bsf", y, w1) + b1)
        return torch.einsum("bsf,fd->bsd", h, w2) + b2

    x = A_x
    xn = _layernorm(x, axis=-1)
    return x + _A_ref(xn, A_k_cache, A_v_cache, A_wq, A_wo) + _B_ref(xn, B_w1, B_b1, B_w2, B_b2)
```

```asm
; @launch grid=(256,1,1) block=(768,1,1) lds=26624
.amdgcn_target "amdgcn-amd-amdhsa--gfx950"
.text
.globl parallel_sum__sliding_block_cached__mixer_channel_mlp__decode_kernel
.p2align 10
.fill 64, 4, 0xbf800000
.p2align 8
.type parallel_sum__sliding_block_cached__mixer_channel_mlp__decode_kernel,@function
parallel_sum__sliding_block_cached__mixer_channel_mlp__decode_kernel:
    s_load_dwordx16 s[8:23], s[0:1], 0
    s_load_dwordx8 s[24:31], s[0:1], 64
    s_load_dwordx2 s[32:33], s[0:1], 96
    s_cmp_ge_u32 s2, 256
    s_cbranch_scc1 L_end
    v_lshrrev_b32 v2, 6, v0
    v_and_b32 v1, 63, v0
    v_readfirstlane_b32 s3, v2
    s_and_b32 s4, s2, 7
    s_lshl_b32 s4, s4, 2
    s_bfe_u32 s5, s2, 0x20003
    s_add_u32 s4, s4, s5
    s_lshr_b32 s5, s2, 5
    s_lshl_b32 s34, s4, 3
    s_add_u32 s34, s34, s5
    v_lshlrev_b32 v3, 4, v1
    v_lshrrev_b32 v8, 4, v1
    v_and_b32 v9, 15, v1
    s_lshl_b32 s6, s34, 9
    s_cmp_eq_u32 s3, 0
    s_cbranch_scc1 L_H0a
    s_cmp_eq_u32 s3, 1
    s_cbranch_scc1 L_H1a
    s_lshr_b32 s7, s3, 2
    s_cmp_eq_u32 s7, 1
    s_cbranch_scc1 L_S0
    v_mov_b32 v10, 0
    v_mov_b32 v11, 0
    v_lshlrev_b32 v2, 3, v1
    v_and_b32 v2, 56, v2
    ds_write_b64 v2, v[10:11]
    s_waitcnt lgkmcnt(0)
    s_barrier
    s_branch L_rest
L_H0a:
    s_lshl_b32 s48, s5, 19
    s_lshl_b32 s49, s4, 8
    s_add_u32 s48, s48, s49
    v_lshlrev_b32 v10, 17, v8
    v_lshl_or_b32 v10, v9, 4, v10
    s_mov_b32 s49, 0
    v_mov_b32 v56, -1
    v_mov_b32 v57, -1
    v_mov_b32 v58, -1
    v_mov_b32 v59, -1
    s_add_u32 s50, s6, 393216
    s_waitcnt lgkmcnt(0)
    s_mov_b32 s36, s32
    s_mov_b32 s37, s33
    s_mov_b32 s38, 0x100000
    s_mov_b32 s39, 0x20000
    s_add_u32 s40, s14, s48
    s_addc_u32 s41, s15, 0
    s_sub_u32 s42, 4194304, s48
    s_mov_b32 s43, 0x20000
    s_mov_b32 exec_hi, 0
    buffer_store_dwordx4 v[56:59], v3, s[36:39], s50 offen
    s_mov_b32 exec_hi, -1
    global_load_dwordx4 v[12:15], v3, s[8:9]
    buffer_load_dwordx4 v[64:67], v10, s[40:43], s49 offen nt
    s_addk_i32 s49, 0x2000
    buffer_load_dwordx4 v[68:71], v10, s[40:43], s49 offen nt
    s_addk_i32 s49, 0x2000
    buffer_load_dwordx4 v[72:75], v10, s[40:43], s49 offen nt
    s_addk_i32 s49, 0x2000
    buffer_load_dwordx4 v[76:79], v10, s[40:43], s49 offen nt
    s_addk_i32 s49, 0x2000
    buffer_load_dwordx4 v[80:83], v10, s[40:43], s49 offen nt
    s_addk_i32 s49, 0x2000
    buffer_load_dwordx4 v[84:87], v10, s[40:43], s49 offen nt
    s_addk_i32 s49, 0x2000
    buffer_load_dwordx4 v[88:91], v10, s[40:43], s49 offen nt
    s_addk_i32 s49, 0x2000
    buffer_load_dwordx4 v[92:95], v10, s[40:43], s49 offen nt
    s_addk_i32 s49, 0x2000
    buffer_load_dwordx4 v[96:99], v10, s[40:43], s49 offen nt
    s_addk_i32 s49, 0x2000
    buffer_load_dwordx4 v[100:103], v10, s[40:43], s49 offen nt
    s_addk_i32 s49, 0x2000
    buffer_load_dwordx4 v[104:107], v10, s[40:43], s49 offen nt
    s_addk_i32 s49, 0x2000
    buffer_load_dwordx4 v[108:111], v10, s[40:43], s49 offen nt
    s_addk_i32 s49, 0x2000
    buffer_load_dwordx4 v[112:115], v10, s[40:43], s49 offen nt
    s_addk_i32 s49, 0x2000
    buffer_load_dwordx4 v[116:119], v10, s[40:43], s49 offen nt
    s_addk_i32 s49, 0x2000
    buffer_load_dwordx4 v[120:123], v10, s[40:43], s49 offen nt
    s_addk_i32 s49, 0x2000
    buffer_load_dwordx4 v[124:127], v10, s[40:43], s49 offen nt
    s_barrier
    s_branch L_H0b
L_H1a:
    s_lshr_b32 s48, s4, 3
    s_lshl_b32 s48, s48, 2
    s_and_b32 s49, s4, 3
    s_add_u32 s48, s48, s49
    s_min_u32 s49, s48, 12
    s_mul_i32 s56, s48, 2
    s_add_u32 s56, s56, s49
    s_add_u32 s56, s56, 128
    s_cmp_lt_u32 s48, 12
    s_cselect_b32 s57, 3, 2
    s_mul_i32 s48, s48, 8
    s_bitcmp0_b32 s2, 0
    s_cselect_b32 s56, s48, s56
    s_cselect_b32 s57, 8, s57
    s_bfm_b32 s88, s57, 0
    s_mul_i32 s88, s88, 0x01010101
    s_mov_b32 s89, s88
    s_lshl_b32 s57, s57, 3
    s_sub_u32 s57, 64, s57
    s_lshr_b64 s[58:59], -1, s57
    s_mul_i32 s48, s5, 176128
    s_lshl_b32 s49, s56, 4
    s_add_u32 s48, s48, s49
    s_lshl_b32 s50, s56, 13
    s_lshl_b32 s51, s5, 7
    s_add_u32 s50, s50, s51
    v_and_b32 v10, 56, v1
    v_and_b32 v11, 7, v1
    v_lshlrev_b32 v11, 4, v11
    s_movk_i32 s51, 2752
    v_mad_u32_u24 v60, v10, s51, v11
    v_lshl_or_b32 v61, v10, 10, v11
    v_lshlrev_b32 v62, 1, v10
    v_lshlrev_b32 v10, 1, v1
    s_mov_b32 s52, 0
    s_movk_i32 s53, 4096
    s_waitcnt lgkmcnt(0)
    s_add_u32 s40, s20, s48
    s_addc_u32 s41, s21, 0
    s_sub_u32 s42, 1409024, s48
    s_mov_b32 s43, 0x20000
    global_load_dwordx4 v[12:15], v3, s[8:9]
    s_mov_b64 exec, s[88:89]
    buffer_load_dwordx4 v[64:67], v60, s[40:43], s52 offen nt
    s_add_u32 s52, s52, s51
    buffer_load_dwordx4 v[68:71], v60, s[40:43], s52 offen nt
    s_add_u32 s52, s52, s51
    buffer_load_dwordx4 v[72:75], v60, s[40:43], s52 offen nt
    s_add_u32 s52, s52, s51
    buffer_load_dwordx4 v[76:79], v60, s[40:43], s52 offen nt
    s_add_u32 s52, s52, s51
    buffer_load_dwordx4 v[80:83], v60, s[40:43], s52 offen nt
    s_add_u32 s52, s52, s51
    buffer_load_dwordx4 v[84:87], v60, s[40:43], s52 offen nt
    s_add_u32 s52, s52, s51
    buffer_load_dwordx4 v[88:91], v60, s[40:43], s52 offen nt
    s_add_u32 s52, s52, s51
    buffer_load_dwordx4 v[92:95], v60, s[40:43], s52 offen nt
    s_mov_b64 exec, s[58:59]
    s_add_u32 s40, s24, s50
    s_addc_u32 s41, s25, 0
    s_sub_u32 s42, 1409024, s50
    s_mov_b32 s43, 0x20000
    buffer_load_dwordx4 v[96:99], v61, s[40:43], 0 offen offset:0 nt
    buffer_load_dwordx4 v[100:103], v61, s[40:43], 0 offen offset:1024 nt
    buffer_load_dwordx4 v[104:107], v61, s[40:43], 0 offen offset:2048 nt
    buffer_load_dwordx4 v[108:111], v61, s[40:43], 0 offen offset:3072 nt
    buffer_load_dwordx4 v[112:115], v61, s[40:43], s53 offen offset:0 nt
    buffer_load_dwordx4 v[116:119], v61, s[40:43], s53 offen offset:1024 nt
    buffer_load_dwordx4 v[120:123], v61, s[40:43], s53 offen offset:2048 nt
    buffer_load_dwordx4 v[124:127], v61, s[40:43], s53 offen offset:3072 nt
    s_add_u32 s40, s22, s49
    s_addc_u32 s41, s23, 0
    s_sub_u32 s42, 2752, s49
    s_mov_b32 s43, 0x20000
    buffer_load_ushort v63, v10, s[40:43], 0 offen
    s_mov_b64 exec, -1
    s_barrier
    s_branch L_H1b
L_S0:
L_S:
    s_sub_u32 s6, s3, 4
    s_lshl_b32 s48, s4, 22
    s_lshl_b32 s49, s5, 17
    s_add_u32 s48, s48, s49
    s_lshl_b32 s49, s6, 14
    s_add_u32 s48, s48, s49
    s_add_u32 s48, s48, 0x300000
    s_lshr_b32 s50, s6, 1
    s_mul_i32 s50, s50, 8
    s_lshr_b32 s51, s2, 3
    s_add_u32 s50, s50, s51
    s_lshl_b32 s50, s50, 10
    s_movk_i32 s51, 0x3c00
    v_lshlrev_b32 v3, 4, v1
    v_and_b32 v2, 48, v3
    v_bfe_u32 v10, v1, 2, 2
    v_lshl_or_b32 v2, v10, 8, v2
    v_lshl_or_b32 v2, v8, 6, v2
    s_waitcnt lgkmcnt(0)
    s_add_u32 s40, s10, s48
    s_addc_u32 s41, s11, 0
    s_mov_b32 s42, 16384
    s_mov_b32 s43, 0x20000
    s_add_u32 s44, s12, s48
    s_addc_u32 s45, s13, 0
    s_mov_b32 s46, 16384
    s_mov_b32 s47, 0x20000
    s_cmp_lg_u32 s7, 1
    s_cbranch_scc1 L_Sgo
    s_barrier
L_Sgo:
    s_and_b32 s52, s50, s51
    buffer_load_dwordx4 v[40:43], v2, s[40:43], s52 offen nt
    s_addk_i32 s50, 0x400
    s_and_b32 s52, s50, s51
    buffer_load_dwordx4 v[44:47], v2, s[40:43], s52 offen nt
    s_addk_i32 s50, 0x400
    s_and_b32 s52, s50, s51
    buffer_load_dwordx4 v[48:51], v2, s[40:43], s52 offen nt
    s_addk_i32 s50, 0x400
    s_and_b32 s52, s50, s51
    buffer_load_dwordx4 v[52:55], v2, s[40:43], s52 offen nt
    s_addk_i32 s50, 0x400
    s_and_b32 s52, s50, s51
    buffer_load_dwordx4 v[56:59], v2, s[40:43], s52 offen nt
    s_addk_i32 s50, 0x400
    s_and_b32 s52, s50, s51
    buffer_load_dwordx4 v[60:63], v2, s[40:43], s52 offen nt
    s_addk_i32 s50, 0x400
    s_and_b32 s52, s50, s51
    buffer_load_dwordx4 v[64:67], v2, s[40:43], s52 offen nt
    s_addk_i32 s50, 0x400
    s_and_b32 s52, s50, s51
    buffer_load_dwordx4 v[68:71], v2, s[40:43], s52 offen nt
    s_addk_i32 s50, 0x400
    s_and_b32 s52, s50, s51
    buffer_load_dwordx4 v[72:75], v2, s[40:43], s52 offen nt
    s_addk_i32 s50, 0x400
    s_and_b32 s52, s50, s51
    buffer_load_dwordx4 v[76:79], v2, s[40:43], s52 offen nt
    s_addk_i32 s50, 0x400
    s_waitcnt vmcnt(9)
    s_and_b32 s52, s50, s51
    buffer_load_dwordx4 v[80:83], v2, s[40:43], s52 offen nt
    s_addk_i32 s50, 0x400
    s_waitcnt vmcnt(9)
    s_and_b32 s52, s50, s51
    buffer_load_dwordx4 v[84:87], v2, s[40:43], s52 offen nt
    s_addk_i32 s50, 0x400
    s_waitcnt vmcnt(9)
    s_and_b32 s52, s50, s51
    buffer_load_dwordx4 v[88:91], v2, s[40:43], s52 offen nt
    s_addk_i32 s50, 0x400
    s_waitcnt vmcnt(9)
    s_and_b32 s52, s50, s51
    buffer_load_dwordx4 v[92:95], v2, s[40:43], s52 offen nt
    s_addk_i32 s50, 0x400
    s_waitcnt vmcnt(9)
    s_and_b32 s52, s50, s51
    buffer_load_dwordx4 v[96:99], v2, s[40:43], s52 offen nt
    s_addk_i32 s50, 0x400
    s_waitcnt vmcnt(9)
    s_and_b32 s52, s50, s51
    buffer_load_dwordx4 v[100:103], v2, s[40:43], s52 offen nt
    s_addk_i32 s50, 0x400
    s_waitcnt vmcnt(9)
    s_and_b32 s52, s50, s51
    buffer_load_dwordx4 v[104:107], v3, s[44:47], s52 offen nt
    s_addk_i32 s50, 0x400
    s_waitcnt vmcnt(9)
    s_and_b32 s52, s50, s51
    buffer_load_dwordx4 v[108:111], v3, s[44:47], s52 offen nt
    s_addk_i32 s50, 0x400
    s_waitcnt vmcnt(9)
    s_and_b32 s52, s50, s51
    buffer_load_dwordx4 v[112:115], v3, s[44:47], s52 offen nt
    s_addk_i32 s50, 0x400
    s_waitcnt vmcnt(9)
    s_and_b32 s52, s50, s51
L_hop0:
    s_cbranch_execz L_hop6
    buffer_load_dwordx4 v[116:119], v3, s[44:47], s52 offen nt
    s_addk_i32 s50, 0x400
    s_waitcnt vmcnt(9)
    s_and_b32 s52, s50, s51
    buffer_load_dwordx4 v[120:123], v3, s[44:47], s52 offen nt
    s_addk_i32 s50, 0x400
    s_waitcnt vmcnt(9)
    s_and_b32 s52, s50, s51
    buffer_load_dwordx4 v[124:127], v3, s[44:47], s52 offen nt
    s_addk_i32 s50, 0x400
    s_waitcnt vmcnt(9)
    s_and_b32 s52, s50, s51
    buffer_load_dwordx4 v[128:131], v3, s[44:47], s52 offen nt
    s_addk_i32 s50, 0x400
    s_waitcnt vmcnt(9)
    s_and_b32 s52, s50, s51
    buffer_load_dwordx4 v[132:135], v3, s[44:47], s52 offen nt
    s_addk_i32 s50, 0x400
    s_waitcnt vmcnt(9)
    s_and_b32 s52, s50, s51
    buffer_load_dwordx4 v[136:139], v3, s[44:47], s52 offen nt
    s_addk_i32 s50, 0x400
    s_waitcnt vmcnt(9)
    s_and_b32 s52, s50, s51
    buffer_load_dwordx4 v[140:143], v3, s[44:47], s52 offen nt
    s_addk_i32 s50, 0x400
    s_and_b32 s52, s50, s51
    buffer_load_dwordx4 v[144:147], v3, s[44:47], s52 offen nt
    s_addk_i32 s50, 0x400
    s_and_b32 s52, s50, s51
    buffer_load_dwordx4 v[148:151], v3, s[44:47], s52 offen nt
    s_addk_i32 s50, 0x400
    s_and_b32 s52, s50, s51
    buffer_load_dwordx4 v[152:155], v3, s[44:47], s52 offen nt
    s_addk_i32 s50, 0x400
    s_and_b32 s52, s50, s51
    buffer_load_dwordx4 v[156:159], v3, s[44:47], s52 offen nt
    s_addk_i32 s50, 0x400
    s_and_b32 s52, s50, s51
    buffer_load_dwordx4 v[160:163], v3, s[44:47], s52 offen nt
    s_addk_i32 s50, 0x400
    s_and_b32 s52, s50, s51
    buffer_load_dwordx4 v[164:167], v3, s[44:47], s52 offen nt
    s_and_b32 s52, s6, 3
    s_lshl_b32 s52, s52, 2
    v_mov_b32 v8, s52
    v_mov_b32 v9, 1
    s_mov_b64 exec, 1
    ds_add_u32 v8, v9 offset:16
    s_mov_b64 exec, -1
    v_and_b32 v10, 1, v1
    v_lshlrev_b32 v10, 4, v10
    v_mov_b32 v11, 0xffff
    v_lshlrev_b32 v11, v10, v11
    v_bfe_u32 v10, v1, 1, 2
    v_cmp_eq_u32 vcc, 0, v10
    s_nop 1
    v_cndmask_b32 v4, 0, v11, vcc
    v_cmp_eq_u32 vcc, 1, v10
    s_nop 1
    v_cndmask_b32 v5, 0, v11, vcc
    v_cmp_eq_u32 vcc, 2, v10
    s_nop 1
    v_cndmask_b32 v6, 0, v11, vcc
    v_cmp_eq_u32 vcc, 3, v10
    s_nop 1
    v_cndmask_b32 v7, 0, v11, vcc
    s_mov_b32 s48, 0xf000f
    s_mov_b32 s49, s48
    s_mov_b32 s50, 0xf000f0
    s_mov_b32 s51, s50
    s_mov_b32 s52, 0xf000f00
    s_mov_b32 s53, s52
    s_mov_b32 s54, 0xf000f000
    s_mov_b32 s55, s54
    s_mov_b32 s56, 0x22222222
    s_mov_b32 s57, s56
    s_mov_b32 s58, 0x44444444
    s_mov_b32 s59, s58
    s_mov_b32 s60, 0x88888888
    s_mov_b32 s61, s60
    v_lshrrev_b32 v10, 4, v1
    v_lshlrev_b32 v10, 6, v10
    v_and_b32 v11, 3, v1
    v_lshl_or_b32 v10, v11, 4, v10
    v_mov_b32 v8, 0
    s_mov_b32 s25, 0x200000
L_sp_1:
    ds_read_b32 v9, v8 offset:0
    s_waitcnt lgkmcnt(0)
    v_readfirstlane_b32 s24, v9
    s_nop 1
    s_cmp_eq_u32 s24, 1
    s_cbranch_scc1 L_spd_2
    s_sleep 1
    s_sub_u32 s25, s25, 1
    s_cbranch_scc0 L_sp_1
    s_endpgm
L_spd_2:
    ds_read_b128 v[24:27], v10 offset:128
    s_waitcnt lgkmcnt(0)
    v_cndmask_b32 v8, 0, v24, s[48:49]
    v_cndmask_b32 v9, 0, v25, s[48:49]
    v_cndmask_b32 v10, 0, v26, s[48:49]
    v_cndmask_b32 v11, 0, v27, s[48:49]
    v_cndmask_b32 v12, 0, v24, s[50:51]
    v_cndmask_b32 v13, 0, v25, s[50:51]
    v_cndmask_b32 v14, 0, v26, s[50:51]
    v_cndmask_b32 v15, 0, v27, s[50:51]
    v_cndmask_b32 v16, 0, v24, s[52:53]
    v_cndmask_b32 v17, 0, v25, s[52:53]
    v_cndmask_b32 v18, 0, v26, s[52:53]
    v_cndmask_b32 v19, 0, v27, s[52:53]
    v_cndmask_b32 v20, 0, v24, s[54:55]
    v_cndmask_b32 v21, 0, v25, s[54:55]
    v_cndmask_b32 v22, 0, v26, s[54:55]
    v_cndmask_b32 v23, 0, v27, s[54:55]
    v_mfma_f32_16x16x32_bf16 v[24:27], v[40:43], v[8:11], 0
    v_mfma_f32_16x16x32_bf16 v[28:31], v[56:59], v[8:11], 0
    v_mfma_f32_16x16x32_bf16 v[32:35], v[72:75], v[8:11], 0
    v_mfma_f32_16x16x32_bf16 v[36:39], v[88:91], v[8:11], 0
    v_mfma_f32_16x16x32_bf16 v[24:27], v[44:47], v[12:15], v[24:27]
    v_mfma_f32_16x16x32_bf16 v[28:31], v[60:63], v[12:15], v[28:31]
    v_mfma_f32_16x16x32_bf16 v[32:35], v[76:79], v[12:15], v[32:35]
    v_mfma_f32_16x16x32_bf16 v[36:39], v[92:95], v[12:15], v[36:39]
    v_mfma_f32_16x16x32_bf16 v[24:27], v[48:51], v[16:19], v[24:27]
    v_mfma_f32_16x16x32_bf16 v[28:31], v[64:67], v[16:19], v[28:31]
    v_mfma_f32_16x16x32_bf16 v[32:35], v[80:83], v[16:19], v[32:35]
    v_mfma_f32_16x16x32_bf16 v[36:39], v[96:99], v[16:19], v[36:39]
    v_mfma_f32_16x16x32_bf16 v[24:27], v[52:55], v[20:23], v[24:27]
    v_mfma_f32_16x16x32_bf16 v[28:31], v[68:71], v[20:23], v[28:31]
    v_mfma_f32_16x16x32_bf16 v[32:35], v[84:87], v[20:23], v[32:35]
    v_mfma_f32_16x16x32_bf16 v[36:39], v[100:103], v[20:23], v[36:39]
    s_nop 4
    v_cndmask_b32 v24, v24, v25, s[56:57]
    v_cndmask_b32 v28, v28, v29, s[56:57]
    v_cndmask_b32 v32, v32, v33, s[56:57]
    v_cndmask_b32 v36, v36, v37, s[56:57]
    v_cndmask_b32 v24, v24, v26, s[58:59]
    v_cndmask_b32 v28, v28, v30, s[58:59]
    v_cndmask_b32 v32, v32, v34, s[58:59]
    v_cndmask_b32 v36, v36, v38, s[58:59]
    v_cndmask_b32 v24, v24, v27, s[60:61]
    v_cndmask_b32 v28, v28, v31, s[60:61]
    v_cndmask_b32 v32, v32, v35, s[60:61]
    v_cndmask_b32 v36, v36, v39, s[60:61]
    v_add_f32_dpp v8, v24, v24 quad_perm:[1,0,3,2] row_mask:0xf bank_mask:0xf
    v_add_f32_dpp v9, v28, v28 quad_perm:[1,0,3,2] row_mask:0xf bank_mask:0xf
    v_add_f32_dpp v10, v32, v32 quad_perm:[1,0,3,2] row_mask:0xf bank_mask:0xf
    v_add_f32_dpp v11, v36, v36 quad_perm:[1,0,3,2] row_mask:0xf bank_mask:0xf
    v_add_f32_dpp v8, v8, v8 quad_perm:[2,3,0,1] row_mask:0xf bank_mask:0xf
    v_add_f32_dpp v9, v9, v9 quad_perm:[2,3,0,1] row_mask:0xf bank_mask:0xf
    v_add_f32_dpp v10, v10, v10 quad_perm:[2,3,0,1] row_mask:0xf bank_mask:0xf
    v_add_f32_dpp v11, v11, v11 quad_perm:[2,3,0,1] row_mask:0xf bank_mask:0xf
    v_cvt_pk_bf16_f32 v12, v8, v9
    v_cvt_pk_bf16_f32 v13, v10, v11
    v_lshlrev_b32 v8, 16, v12
    v_and_b32 v9, 0xffff0000, v12
    v_lshlrev_b32 v10, 16, v13
    v_and_b32 v11, 0xffff0000, v13
    v_mul_f32 v8, 0x3db504f3, v8
    v_mul_f32 v9, 0x3db504f3, v9
    v_mul_f32 v10, 0x3db504f3, v10
    v_mul_f32 v11, 0x3db504f3, v11
    v_cvt_pk_bf16_f32 v12, v8, v9
    v_cvt_pk_bf16_f32 v13, v10, v11
    v_lshlrev_b32 v8, 16, v12
    v_and_b32 v9, 0xffff0000, v12
    v_lshlrev_b32 v10, 16, v13
L_hop1:
    s_cbranch_execz L_hop7
    v_and_b32 v11, 0xffff0000, v13
    v_max3_f32 v14, v8, v9, v10
    v_max_f32 v14, v14, v11
    s_nop 1
    v_max_f32_dpp v14, v14, v14 row_ror:8 row_mask:0xf bank_mask:0xf
    s_nop 1
    v_max_f32_dpp v14, v14, v14 row_ror:4 row_mask:0xf bank_mask:0xf
    v_mov_b32 v16, v14
    s_nop 1
    v_permlane16_swap_b32 v14, v16
    v_max_f32 v14, v14, v16
    v_mov_b32 v16, v14
    s_nop 1
    v_permlane32_swap_b32 v14, v16
    v_max_f32 v14, v14, v16
    v_sub_f32 v8, v8, v14
    v_sub_f32 v9, v9, v14
    v_sub_f32 v10, v10, v14
    v_sub_f32 v11, v11, v14
    v_mul_f32 v8, 0x3fb8aa3b, v8
    v_mul_f32 v9, 0x3fb8aa3b, v9
    v_mul_f32 v10, 0x3fb8aa3b, v10
    v_mul_f32 v11, 0x3fb8aa3b, v11
    v_exp_f32 v8, v8
    v_exp_f32 v9, v9
    v_exp_f32 v10, v10
    v_exp_f32 v11, v11
    v_add_f32 v15, v8, v9
    v_add_f32 v16, v10, v11
    v_add_f32 v15, v15, v16
    v_cvt_pk_bf16_f32 v8, v8, v8
    v_cvt_pk_bf16_f32 v9, v9, v9
    v_cvt_pk_bf16_f32 v10, v10, v10
    v_cvt_pk_bf16_f32 v11, v11, v11
    v_add_f32_dpp v15, v15, v15 row_ror:8 row_mask:0xf bank_mask:0xf
    s_nop 1
    v_add_f32_dpp v15, v15, v15 row_ror:4 row_mask:0xf bank_mask:0xf
    v_mov_b32 v16, v15
    s_nop 1
    v_permlane16_swap_b32 v15, v16
    v_add_f32 v15, v15, v16
    v_mov_b32 v16, v15
    s_nop 1
    v_permlane32_swap_b32 v15, v16
    v_add_f32 v15, v15, v16
    s_lshl_b32 s24, s6, 3
    v_mov_b32 v16, s24
    v_mov_b32 v17, 0
    v_mov_b32 v18, 1
    s_mov_b64 exec, 1
    ds_write_b64 v16, v[14:15] offset:64
    ds_add_u32 v17, v18 offset:8
    s_mov_b64 exec, -1
    v_and_b32 v16, 15, v1
    v_lshlrev_b32 v16, 5, v16
    v_lshrrev_b32 v17, 4, v1
    v_lshl_or_b32 v16, v17, 4, v16
    s_lshl_b32 s24, s6, 9
    v_add_u32 v16, s24, v16
    s_lshr_b32 s24, s6, 2
    s_lshl_b32 s24, s24, 3
    v_mov_b32 v19, s24
    v_and_b32_dpp v40, v8, v4 row_newbcast:0 row_mask:0xf bank_mask:0xf
    v_and_b32_dpp v41, v8, v5 row_newbcast:0 row_mask:0xf bank_mask:0xf
    v_and_b32_dpp v42, v8, v6 row_newbcast:0 row_mask:0xf bank_mask:0xf
    v_and_b32_dpp v43, v8, v7 row_newbcast:0 row_mask:0xf bank_mask:0xf
    v_and_b32_dpp v44, v8, v4 row_newbcast:4 row_mask:0xf bank_mask:0xf
    v_and_b32_dpp v45, v8, v5 row_newbcast:4 row_mask:0xf bank_mask:0xf
    v_and_b32_dpp v46, v8, v6 row_newbcast:4 row_mask:0xf bank_mask:0xf
    v_and_b32_dpp v47, v8, v7 row_newbcast:4 row_mask:0xf bank_mask:0xf
    v_and_b32_dpp v48, v8, v4 row_newbcast:8 row_mask:0xf bank_mask:0xf
    v_and_b32_dpp v49, v8, v5 row_newbcast:8 row_mask:0xf bank_mask:0xf
    v_and_b32_dpp v50, v8, v6 row_newbcast:8 row_mask:0xf bank_mask:0xf
    v_and_b32_dpp v51, v8, v7 row_newbcast:8 row_mask:0xf bank_mask:0xf
    v_and_b32_dpp v52, v8, v4 row_newbcast:12 row_mask:0xf bank_mask:0xf
    v_and_b32_dpp v53, v8, v5 row_newbcast:12 row_mask:0xf bank_mask:0xf
    v_and_b32_dpp v54, v8, v6 row_newbcast:12 row_mask:0xf bank_mask:0xf
    v_and_b32_dpp v55, v8, v7 row_newbcast:12 row_mask:0xf bank_mask:0xf
    v_and_b32_dpp v56, v9, v4 row_newbcast:0 row_mask:0xf bank_mask:0xf
    v_and_b32_dpp v57, v9, v5 row_newbcast:0 row_mask:0xf bank_mask:0xf
    v_and_b32_dpp v58, v9, v6 row_newbcast:0 row_mask:0xf bank_mask:0xf
    v_and_b32_dpp v59, v9, v7 row_newbcast:0 row_mask:0xf bank_mask:0xf
    v_and_b32_dpp v60, v9, v4 row_newbcast:4 row_mask:0xf bank_mask:0xf
    v_and_b32_dpp v61, v9, v5 row_newbcast:4 row_mask:0xf bank_mask:0xf
    v_and_b32_dpp v62, v9, v6 row_newbcast:4 row_mask:0xf bank_mask:0xf
    v_and_b32_dpp v63, v9, v7 row_newbcast:4 row_mask:0xf bank_mask:0xf
    v_and_b32_dpp v64, v9, v4 row_newbcast:8 row_mask:0xf bank_mask:0xf
    v_and_b32_dpp v65, v9, v5 row_newbcast:8 row_mask:0xf bank_mask:0xf
    v_and_b32_dpp v66, v9, v6 row_newbcast:8 row_mask:0xf bank_mask:0xf
    v_and_b32_dpp v67, v9, v7 row_newbcast:8 row_mask:0xf bank_mask:0xf
    v_and_b32_dpp v68, v9, v4 row_newbcast:12 row_mask:0xf bank_mask:0xf
    v_and_b32_dpp v69, v9, v5 row_newbcast:12 row_mask:0xf bank_mask:0xf
    v_and_b32_dpp v70, v9, v6 row_newbcast:12 row_mask:0xf bank_mask:0xf
    v_and_b32_dpp v71, v9, v7 row_newbcast:12 row_mask:0xf bank_mask:0xf
    v_and_b32_dpp v72, v10, v4 row_newbcast:0 row_mask:0xf bank_mask:0xf
    v_and_b32_dpp v73, v10, v5 row_newbcast:0 row_mask:0xf bank_mask:0xf
    v_and_b32_dpp v74, v10, v6 row_newbcast:0 row_mask:0xf bank_mask:0xf
    v_and_b32_dpp v75, v10, v7 row_newbcast:0 row_mask:0xf bank_mask:0xf
    v_and_b32_dpp v76, v10, v4 row_newbcast:4 row_mask:0xf bank_mask:0xf
    v_and_b32_dpp v77, v10, v5 row_newbcast:4 row_mask:0xf bank_mask:0xf
    v_and_b32_dpp v78, v10, v6 row_newbcast:4 row_mask:0xf bank_mask:0xf
    v_and_b32_dpp v79, v10, v7 row_newbcast:4 row_mask:0xf bank_mask:0xf
    v_and_b32_dpp v80, v10, v4 row_newbcast:8 row_mask:0xf bank_mask:0xf
    v_and_b32_dpp v81, v10, v5 row_newbcast:8 row_mask:0xf bank_mask:0xf
    v_and_b32_dpp v82, v10, v6 row_newbcast:8 row_mask:0xf bank_mask:0xf
    v_and_b32_dpp v83, v10, v7 row_newbcast:8 row_mask:0xf bank_mask:0xf
    v_and_b32_dpp v84, v10, v4 row_newbcast:12 row_mask:0xf bank_mask:0xf
    v_and_b32_dpp v85, v10, v5 row_newbcast:12 row_mask:0xf bank_mask:0xf
    v_and_b32_dpp v86, v10, v6 row_newbcast:12 row_mask:0xf bank_mask:0xf
    v_and_b32_dpp v87, v10, v7 row_newbcast:12 row_mask:0xf bank_mask:0xf
    v_and_b32_dpp v88, v11, v4 row_newbcast:0 row_mask:0xf bank_mask:0xf
    v_and_b32_dpp v89, v11, v5 row_newbcast:0 row_mask:0xf bank_mask:0xf
    v_and_b32_dpp v90, v11, v6 row_newbcast:0 row_mask:0xf bank_mask:0xf
    v_and_b32_dpp v91, v11, v7 row_newbcast:0 row_mask:0xf bank_mask:0xf
    v_and_b32_dpp v92, v11, v4 row_newbcast:4 row_mask:0xf bank_mask:0xf
    v_and_b32_dpp v93, v11, v5 row_newbcast:4 row_mask:0xf bank_mask:0xf
    v_and_b32_dpp v94, v11, v6 row_newbcast:4 row_mask:0xf bank_mask:0xf
    v_and_b32_dpp v95, v11, v7 row_newbcast:4 row_mask:0xf bank_mask:0xf
    v_and_b32_dpp v96, v11, v4 row_newbcast:8 row_mask:0xf bank_mask:0xf
    v_and_b32_dpp v97, v11, v5 row_newbcast:8 row_mask:0xf bank_mask:0xf
    v_and_b32_dpp v98, v11, v6 row_newbcast:8 row_mask:0xf bank_mask:0xf
    v_and_b32_dpp v99, v11, v7 row_newbcast:8 row_mask:0xf bank_mask:0xf
    v_and_b32_dpp v100, v11, v4 row_newbcast:12 row_mask:0xf bank_mask:0xf
    v_and_b32_dpp v101, v11, v5 row_newbcast:12 row_mask:0xf bank_mask:0xf
    v_and_b32_dpp v102, v11, v6 row_newbcast:12 row_mask:0xf bank_mask:0xf
    v_and_b32_dpp v103, v11, v7 row_newbcast:12 row_mask:0xf bank_mask:0xf
    v_mov_b32 v17, 0
    s_waitcnt vmcnt(15)
    v_mfma_f32_16x16x32_bf16 v[24:27], v[40:43], v[104:107], 0
    s_waitcnt vmcnt(14)
    v_mfma_f32_16x16x32_bf16 v[24:27], v[44:47], v[108:111], v[24:27]
    s_waitcnt vmcnt(13)
    v_mfma_f32_16x16x32_bf16 v[24:27], v[48:51], v[112:115], v[24:27]
    s_waitcnt vmcnt(12)
    v_mfma_f32_16x16x32_bf16 v[24:27], v[52:55], v[116:119], v[24:27]
    s_waitcnt vmcnt(11)
    v_mfma_f32_16x16x32_bf16 v[24:27], v[56:59], v[120:123], v[24:27]
    s_waitcnt vmcnt(10)
    v_mfma_f32_16x16x32_bf16 v[24:27], v[60:63], v[124:127], v[24:27]
    s_waitcnt vmcnt(9)
    s_mov_b64 exec, 1
    ds_add_u32 v17, v18 offset:32
    s_mov_b64 exec, -1
    v_mfma_f32_16x16x32_bf16 v[24:27], v[64:67], v[128:131], v[24:27]
    s_waitcnt vmcnt(8)
    v_mfma_f32_16x16x32_bf16 v[24:27], v[68:71], v[132:135], v[24:27]
    s_waitcnt vmcnt(7)
    v_mfma_f32_16x16x32_bf16 v[24:27], v[72:75], v[136:139], v[24:27]
    s_waitcnt vmcnt(6)
    v_mfma_f32_16x16x32_bf16 v[24:27], v[76:79], v[140:143], v[24:27]
    s_waitcnt vmcnt(5)
    v_mfma_f32_16x16x32_bf16 v[24:27], v[80:83], v[144:147], v[24:27]
    s_waitcnt vmcnt(4)
    v_mfma_f32_16x16x32_bf16 v[24:27], v[84:87], v[148:151], v[24:27]
    s_waitcnt vmcnt(3)
    v_mfma_f32_16x16x32_bf16 v[24:27], v[88:91], v[152:155], v[24:27]
    s_waitcnt vmcnt(2)
    v_mfma_f32_16x16x32_bf16 v[24:27], v[92:95], v[156:159], v[24:27]
    s_waitcnt vmcnt(1)
L_hop2:
    s_cbranch_execz L_hop8
    v_mfma_f32_16x16x32_bf16 v[24:27], v[96:99], v[160:163], v[24:27]
    s_waitcnt vmcnt(0)
    v_mfma_f32_16x16x32_bf16 v[24:27], v[100:103], v[164:167], v[24:27]
    s_mov_b32 exec_hi, 0
    s_nop 6
    ds_write_b128 v16, v[24:27] offset:4096
    s_mov_b32 exec_lo, 1
    ds_add_u32 v19, v18 offset:4
    s_cmp_eq_u32 s6, 0
    s_cbranch_scc1 L_S0c
    s_endpgm
L_S0c:
    s_mov_b64 exec, -1
    s_mov_b32 s36, s32
    s_mov_b32 s37, s33
    s_mov_b32 s38, 0x100000
    s_mov_b32 s39, 0x20000
    v_mov_b32 v2, 0
    v_lshlrev_b32 v62, 3, v1
    v_lshlrev_b32 v17, 2, v1
    ds_read_b128 v[12:15], v2 offset:48
    s_waitcnt lgkmcnt(0)
    v_readfirstlane_b32 s62, v12
    v_readfirstlane_b32 s63, v13
    v_readfirstlane_b32 s82, v14
    s_lshl_b32 s46, s34, 7
    s_add_u32 s46, s46, 786432
    s_lshl_b32 s47, s34, 9
    s_add_u32 s47, s47, 393216
    s_mov_b32 s51, 0x200000
L_sp_3:
    ds_read_b32 v10, v2 offset:8
    s_waitcnt lgkmcnt(0)
    v_readfirstlane_b32 s48, v10
    s_nop 1
    s_cmp_eq_u32 s48, 8
    s_cbranch_scc1 L_spd_4
    s_sleep 1
    s_sub_u32 s51, s51, 1
    s_cbranch_scc0 L_sp_3
    s_endpgm
L_spd_4:
    ds_read_b128 v[20:23], v2 offset:64
    ds_read_b128 v[24:27], v2 offset:80
    ds_read_b128 v[28:31], v2 offset:96
    ds_read_b128 v[32:35], v2 offset:112
    s_waitcnt lgkmcnt(0)
    v_max3_f32 v40, v20, v22, v24
    v_max3_f32 v40, v40, v26, v28
    v_max3_f32 v40, v40, v30, v32
    v_max_f32 v40, v40, v34
    v_sub_f32 v20, v20, v40
    v_sub_f32 v22, v22, v40
    v_sub_f32 v24, v24, v40
    v_sub_f32 v26, v26, v40
    v_sub_f32 v28, v28, v40
    v_sub_f32 v30, v30, v40
    v_sub_f32 v32, v32, v40
    v_sub_f32 v34, v34, v40
    v_mul_f32 v20, 0x3fb8aa3b, v20
    v_mul_f32 v22, 0x3fb8aa3b, v22
    v_mul_f32 v24, 0x3fb8aa3b, v24
    v_mul_f32 v26, 0x3fb8aa3b, v26
    v_mul_f32 v28, 0x3fb8aa3b, v28
    v_mul_f32 v30, 0x3fb8aa3b, v30
    v_mul_f32 v32, 0x3fb8aa3b, v32
    v_mul_f32 v34, 0x3fb8aa3b, v34
    v_exp_f32 v20, v20
    v_exp_f32 v22, v22
    v_exp_f32 v24, v24
    v_exp_f32 v26, v26
    v_exp_f32 v28, v28
    v_exp_f32 v30, v30
    v_exp_f32 v32, v32
    v_exp_f32 v34, v34
    v_mul_f32 v41, v20, v21
    v_fmac_f32 v41, v22, v23
    v_fmac_f32 v41, v24, v25
    v_fmac_f32 v41, v26, v27
    v_fmac_f32 v41, v28, v29
    v_fmac_f32 v41, v30, v31
    v_fmac_f32 v41, v32, v33
    v_fmac_f32 v41, v34, v35
    v_mov_b32 v42, s62
    v_mov_b32 v43, s63
    s_mov_b64 exec, 1
    s_cmp_lg_u32 s82, 0
    s_cbranch_scc1 L_mls
    buffer_store_dwordx4 v[40:43], v2, s[36:39], s46 offen
    s_branch L_mlt
L_mls:
    buffer_store_dwordx4 v[40:43], v2, s[36:39], s46 offen sc1
L_mlt:
    s_mov_b64 exec, -1
    s_mov_b32 s51, 0x200000
L_sp_5:
    ds_read_b32 v10, v2 offset:4
    s_waitcnt lgkmcnt(0)
    v_readfirstlane_b32 s48, v10
    s_nop 1
    s_cmp_eq_u32 s48, 4
    s_cbranch_scc1 L_spd_6
    s_sleep 1
    s_sub_u32 s51, s51, 1
    s_cbranch_scc0 L_sp_5
    s_endpgm
L_spd_6:
    ds_read_b64 v[44:45], v62 offset:4096
    ds_read_b64 v[46:47], v62 offset:4608
    ds_read_b64 v[48:49], v62 offset:5120
    ds_read_b64 v[50:51], v62 offset:5632
    s_waitcnt lgkmcnt(0)
    v_mul_f32 v36, v20, v44
    v_mul_f32 v37, v20, v45
    v_fmac_f32 v36, v22, v46
    v_fmac_f32 v37, v22, v47
    v_fmac_f32 v36, v24, v48
    v_fmac_f32 v37, v24, v49
    v_fmac_f32 v36, v26, v50
    v_fmac_f32 v37, v26, v51
    s_mov_b32 s51, 0x200000
    s_cmp_lg_u32 s82, 0
    s_cbranch_scc1 L_pbs
L_pbf:
    ds_read_b32 v10, v2 offset:12
    ds_read_b64 v[52:53], v62 offset:6144
    ds_read_b64 v[54:55], v62 offset:6656
    ds_read_b64 v[56:57], v62 offset:7168
    ds_read_b64 v[58:59], v62 offset:7680
    s_waitcnt lgkmcnt(4)
    v_readfirstlane_b32 s48, v10
    s_sub_u32 s51, s51, 1
    s_cbranch_scc1 L_end
    s_cmp_lg_u32 s48, 4
    s_cbranch_scc1 L_pbf
    s_waitcnt lgkmcnt(3)
    v_fmac_f32 v36, v28, v52
    v_fmac_f32 v37, v28, v53
    s_waitcnt lgkmcnt(2)
    v_fmac_f32 v36, v30, v54
    v_fmac_f32 v37, v30, v55
    s_waitcnt lgkmcnt(1)
    v_fmac_f32 v36, v32, v56
    v_fmac_f32 v37, v32, v57
    s_waitcnt lgkmcnt(0)
    v_fmac_f32 v36, v34, v58
    v_fmac_f32 v37, v34, v59
    v_cvt_pk_bf16_f32 v38, v36, v37
    v_lshlrev_b32 v40, 16, v38
    v_and_b32 v41, 0xffff0000, v38
    v_min_u32 v38, -2, v38
    buffer_store_dword v38, v17, s[36:39], s47 offen
    v_sub_f32 v36, v36, v40
    v_sub_f32 v37, v37, v41
    v_cvt_pk_bf16_f32 v39, v36, v37
    v_min_u32 v39, -2, v39
    buffer_store_dword v39, v17, s[36:39], s47 offen offset:256
    s_endpgm
L_pbs:
    ds_read_b32 v10, v2 offset:12
    ds_read_b64 v[52:53], v62 offset:6144
    ds_read_b64 v[54:55], v62 offset:6656
    ds_read_b64 v[56:57], v62 offset:7168
    ds_read_b64 v[58:59], v62 offset:7680
    s_waitcnt lgkmcnt(4)
    v_readfirstlane_b32 s48, v10
    s_sub_u32 s51, s51, 1
    s_cbranch_scc1 L_end
    s_cmp_lg_u32 s48, 4
    s_cbranch_scc1 L_pbs
    s_waitcnt lgkmcnt(3)
    v_fmac_f32 v36, v28, v52
    v_fmac_f32 v37, v28, v53
    s_waitcnt lgkmcnt(2)
    v_fmac_f32 v36, v30, v54
    v_fmac_f32 v37, v30, v55
    s_waitcnt lgkmcnt(1)
    v_fmac_f32 v36, v32, v56
    v_fmac_f32 v37, v32, v57
    s_waitcnt lgkmcnt(0)
    v_fmac_f32 v36, v34, v58
    v_fmac_f32 v37, v34, v59
    v_cvt_pk_bf16_f32 v38, v36, v37
    v_lshlrev_b32 v40, 16, v38
    v_and_b32 v41, 0xffff0000, v38
    v_min_u32 v38, -2, v38
    buffer_store_dword v38, v17, s[36:39], s47 offen sc1
    v_sub_f32 v36, v36, v40
    v_sub_f32 v37, v37, v41
    v_cvt_pk_bf16_f32 v39, v36, v37
L_hop3:
    s_cbranch_execz L_hop9
    v_min_u32 v39, -2, v39
    buffer_store_dword v39, v17, s[36:39], s47 offen offset:256 sc1
    s_endpgm
L_rest:
    s_mov_b64 exec, 0
    s_cmp_eq_u32 s3, 2
    s_cbranch_scc1 L_hop0
    s_cmp_eq_u32 s3, 3
    s_cbranch_scc1 L_hop1
    s_cmp_eq_u32 s3, 8
    s_cbranch_scc1 L_hop2
    s_cmp_eq_u32 s3, 9
    s_cbranch_scc1 L_hop3
    s_cmp_eq_u32 s3, 10
    s_cbranch_scc1 L_hop4
    s_cmp_eq_u32 s3, 11
    s_cbranch_scc1 L_hop5
L_warmret:
    s_mov_b64 exec, -1
    s_cmp_eq_u32 s3, 2
    s_cbranch_scc1 L_Hc0
    s_cmp_eq_u32 s3, 3
    s_cbranch_scc1 L_H3
    s_and_b32 s52, s3, 3
    s_lshl_b32 s52, s52, 2
    v_mov_b32 v10, s52
    s_mov_b32 s50, 0x200000
L_sp_7:
    ds_read_b32 v11, v10 offset:16
    s_waitcnt lgkmcnt(0)
    v_readfirstlane_b32 s48, v11
    s_nop 1
    s_cmp_ge_u32 s48, 1
    s_cbranch_scc1 L_spd_8
    s_sleep 2
    s_sub_u32 s50, s50, 1
    s_cbranch_scc0 L_sp_7
    s_endpgm
L_spd_8:
    s_branch L_S
L_H0b:
    s_load_dwordx2 s[62:63], s[32:33], 819200
    s_mov_b32 s60, 0x01000100
    s_mov_b32 s61, 0x03020302
    v_mov_b32 v2, 0
    v_and_b32 v10, 1, v1
    v_lshlrev_b32 v10, 4, v10
    v_mov_b32 v11, 0xffff
    v_lshlrev_b32 v11, v10, v11
    v_bfe_u32 v10, v1, 1, 2
    v_cmp_eq_u32 vcc, 0, v10
    s_nop 1
    v_cndmask_b32 v4, 0, v11, vcc
    v_cmp_eq_u32 vcc, 1, v10
    s_nop 1
    v_cndmask_b32 v5, 0, v11, vcc
    v_cmp_eq_u32 vcc, 2, v10
    s_nop 1
    v_cndmask_b32 v6, 0, v11, vcc
    v_cmp_eq_u32 vcc, 3, v10
    s_nop 1
    v_cndmask_b32 v7, 0, v11, vcc
    v_and_b32 v50, 1, v8
    v_lshlrev_b32 v50, 5, v50
    v_lshl_or_b32 v50, v9, 6, v50
    v_lshrrev_b32 v11, 1, v8
    v_lshl_or_b32 v50, v11, 4, v50
    s_waitcnt vmcnt(16)
    v_lshlrev_b32 v16, 16, v12
    v_and_b32 v17, 0xffff0000, v12
    v_lshlrev_b32 v18, 16, v13
    v_and_b32 v19, 0xffff0000, v13
    v_lshlrev_b32 v20, 16, v14
    v_and_b32 v21, 0xffff0000, v14
    v_lshlrev_b32 v22, 16, v15
    v_and_b32 v23, 0xffff0000, v15
    v_add_f32 v24, v16, v17
    v_add_f32 v25, v18, v19
    v_add_f32 v26, v20, v21
    v_add_f32 v27, v22, v23
    v_add_f32 v24, v24, v25
    v_add_f32 v26, v26, v27
    v_add_f32 v24, v24, v26
    s_nop 1
    v_add_f32_dpp v24, v24, v24 row_ror:8 row_mask:0xf bank_mask:0xf
    s_nop 1
    v_add_f32_dpp v24, v24, v24 row_ror:4 row_mask:0xf bank_mask:0xf
    s_nop 1
    v_add_f32_dpp v24, v24, v24 row_ror:2 row_mask:0xf bank_mask:0xf
    s_nop 1
    v_add_f32_dpp v24, v24, v24 row_ror:1 row_mask:0xf bank_mask:0xf
    v_mov_b32 v28, v24
    s_nop 1
    v_permlane16_swap_b32 v24, v28
    v_add_f32 v24, v24, v28
    v_mov_b32 v28, v24
    s_nop 1
    v_permlane32_swap_b32 v24, v28
    v_add_f32 v24, v24, v28
    v_mul_f32 v24, 0x3b000000, v24
    v_sub_f32 v26, v16, v24
    v_mul_f32 v25, v26, v26
    v_sub_f32 v27, v17, v24
    v_fmac_f32 v25, v27, v27
    v_sub_f32 v26, v18, v24
    v_fmac_f32 v25, v26, v26
    v_sub_f32 v27, v19, v24
    v_fmac_f32 v25, v27, v27
    v_sub_f32 v26, v20, v24
    v_fmac_f32 v25, v26, v26
    v_sub_f32 v27, v21, v24
    v_fmac_f32 v25, v27, v27
    v_sub_f32 v26, v22, v24
    v_fmac_f32 v25, v26, v26
    v_sub_f32 v27, v23, v24
    v_fmac_f32 v25, v27, v27
    s_nop 1
    v_add_f32_dpp v25, v25, v25 row_ror:8 row_mask:0xf bank_mask:0xf
    s_nop 1
    v_add_f32_dpp v25, v25, v25 row_ror:4 row_mask:0xf bank_mask:0xf
    s_nop 1
    v_add_f32_dpp v25, v25, v25 row_ror:2 row_mask:0xf bank_mask:0xf
    s_nop 1
    v_add_f32_dpp v25, v25, v25 row_ror:1 row_mask:0xf bank_mask:0xf
    v_mov_b32 v28, v25
    s_nop 1
    v_permlane16_swap_b32 v25, v28
    v_add_f32 v25, v25, v28
    v_mov_b32 v28, v25
    s_nop 1
    v_permlane32_swap_b32 v25, v28
    v_add_f32 v25, v25, v28
    v_mul_f32 v25, 0x3b000000, v25
    v_cvt_pk_bf16_f32 v26, v24, v25
    v_lshlrev_b32 v24, 16, v26
    v_and_b32 v25, 0xffff0000, v26
    v_add_f32 v25, 0x3727c5ac, v25
    v_cvt_pk_bf16_f32 v25, v25, v25
    v_and_b32 v25, 0xffff0000, v25
    v_sqrt_f32 v25, v25
    s_nop 0
    v_cvt_pk_bf16_f32 v25, v25, v25
    v_and_b32 v25, 0xffff0000, v25
    v_rcp_f32 v27, v25
    v_sub_f32 v16, v16, v24
    v_sub_f32 v17, v17, v24
    v_sub_f32 v18, v18, v24
    v_sub_f32 v19, v19, v24
    v_sub_f32 v20, v20, v24
    v_sub_f32 v21, v21, v24
    v_sub_f32 v22, v22, v24
    v_sub_f32 v23, v23, v24
    v_cvt_pk_bf16_f32 v12, v16, v17
    v_cvt_pk_bf16_f32 v13, v18, v19
    v_cvt_pk_bf16_f32 v14, v20, v21
    v_cvt_pk_bf16_f32 v15, v22, v23
    v_lshlrev_b32 v16, 16, v12
    v_and_b32 v17, 0xffff0000, v12
    v_lshlrev_b32 v18, 16, v13
    v_and_b32 v19, 0xffff0000, v13
    v_lshlrev_b32 v20, 16, v14
    v_and_b32 v21, 0xffff0000, v14
    v_lshlrev_b32 v22, 16, v15
    v_and_b32 v23, 0xffff0000, v15
    v_mul_f32 v28, v16, v27
    v_fma_f32 v16, -v28, v25, v16
    v_fma_f32 v28, v16, v27, v28
    v_mul_f32 v29, v17, v27
    v_fma_f32 v17, -v29, v25, v17
    v_fma_f32 v29, v17, v27, v29
    v_cvt_pk_bf16_f32 v12, v28, v29
    v_mul_f32 v28, v18, v27
    v_fma_f32 v18, -v28, v25, v18
    v_fma_f32 v28, v18, v27, v28
    v_mul_f32 v29, v19, v27
    v_fma_f32 v19, -v29, v25, v19
    v_fma_f32 v29, v19, v27, v29
    v_cvt_pk_bf16_f32 v13, v28, v29
    v_mul_f32 v28, v20, v27
    v_fma_f32 v20, -v28, v25, v20
    v_fma_f32 v28, v20, v27, v28
    v_mul_f32 v29, v21, v27
    v_fma_f32 v21, -v29, v25, v21
    v_fma_f32 v29, v21, v27, v29
    v_cvt_pk_bf16_f32 v14, v28, v29
    v_mul_f32 v28, v22, v27
    v_fma_f32 v22, -v28, v25, v22
    v_fma_f32 v28, v22, v27, v28
    v_mul_f32 v29, v23, v27
    v_fma_f32 v23, -v29, v25, v23
    v_fma_f32 v29, v23, v27, v29
    v_cvt_pk_bf16_f32 v15, v28, v29
    ds_write_b128 v3, v[12:15] offset:512
    s_lshl_b32 s48, s5, 7
    v_lshlrev_b32 v10, 5, v8
    v_add_u32 v10, s48, v10
    ds_read_b128 v[32:35], v10 offset:512
    ds_read_b128 v[36:39], v10 offset:528
    s_waitcnt lgkmcnt(0)
    s_mul_i32 s62, s62, 0x9e3779b1
    s_add_u32 s62, s62, 0x7f4a7c15
    s_mul_i32 s63, s63, 0x85ebca6d
    s_add_u32 s63, s63, 0xc2b2ae35
    s_getreg_b32 s80, hwreg(HW_REG_XCC_ID)
    s_and_b32 s80, s80, 0xff
    s_xor_b32 s80, s80, s63
    s_xor_b32 s81, s63, 0x100
    s_mov_b32 s82, 0
    v_perm_b32 v48, v32, v32, s60
    v_and_b32 v40, v48, v4
    v_and_b32 v41, v48, v5
    v_and_b32 v42, v48, v6
    v_and_b32 v43, v48, v7
    s_waitcnt vmcnt(15)
    s_nop 0
L_hop4:
    s_cbranch_execz L_warmret
    v_mfma_f32_16x16x32_bf16 v[52:55], v[40:43], v[64:67], 0
    v_perm_b32 v49, v32, v32, s61
    v_and_b32 v44, v49, v4
    v_and_b32 v45, v49, v5
    v_and_b32 v46, v49, v6
    v_and_b32 v47, v49, v7
    s_waitcnt vmcnt(14)
    s_nop 0
    v_mfma_f32_16x16x32_bf16 v[52:55], v[44:47], v[68:71], v[52:55]
    v_perm_b32 v48, v33, v33, s60
    v_and_b32 v40, v48, v4
    v_and_b32 v41, v48, v5
    v_and_b32 v42, v48, v6
    v_and_b32 v43, v48, v7
    s_waitcnt vmcnt(13)
    s_nop 0
    v_mfma_f32_16x16x32_bf16 v[52:55], v[40:43], v[72:75], v[52:55]
    v_perm_b32 v49, v33, v33, s61
    v_and_b32 v44, v49, v4
    v_and_b32 v45, v49, v5
    v_and_b32 v46, v49, v6
    v_and_b32 v47, v49, v7
    s_waitcnt vmcnt(12)
    s_nop 0
    v_mfma_f32_16x16x32_bf16 v[52:55], v[44:47], v[76:79], v[52:55]
    v_perm_b32 v48, v34, v34, s60
    v_and_b32 v40, v48, v4
    v_and_b32 v41, v48, v5
    v_and_b32 v42, v48, v6
    v_and_b32 v43, v48, v7
    s_waitcnt vmcnt(11)
    s_nop 0
    v_mfma_f32_16x16x32_bf16 v[52:55], v[40:43], v[80:83], v[52:55]
    v_perm_b32 v49, v34, v34, s61
    v_and_b32 v44, v49, v4
    v_and_b32 v45, v49, v5
    v_and_b32 v46, v49, v6
    v_and_b32 v47, v49, v7
    s_waitcnt vmcnt(10)
    s_nop 0
    v_mfma_f32_16x16x32_bf16 v[52:55], v[44:47], v[84:87], v[52:55]
    v_perm_b32 v48, v35, v35, s60
    v_and_b32 v40, v48, v4
    v_and_b32 v41, v48, v5
    v_and_b32 v42, v48, v6
    v_and_b32 v43, v48, v7
    s_waitcnt vmcnt(9)
    s_nop 0
    v_mfma_f32_16x16x32_bf16 v[52:55], v[40:43], v[88:91], v[52:55]
    v_perm_b32 v49, v35, v35, s61
    v_and_b32 v44, v49, v4
    v_and_b32 v45, v49, v5
    v_and_b32 v46, v49, v6
    v_and_b32 v47, v49, v7
    s_waitcnt vmcnt(8)
    s_nop 0
    v_mfma_f32_16x16x32_bf16 v[52:55], v[44:47], v[92:95], v[52:55]
    v_perm_b32 v48, v36, v36, s60
    v_and_b32 v40, v48, v4
    v_and_b32 v41, v48, v5
    v_and_b32 v42, v48, v6
    v_and_b32 v43, v48, v7
    s_waitcnt vmcnt(7)
    s_nop 0
    v_mfma_f32_16x16x32_bf16 v[52:55], v[40:43], v[96:99], v[52:55]
    v_perm_b32 v49, v36, v36, s61
    v_and_b32 v44, v49, v4
    v_and_b32 v45, v49, v5
    v_and_b32 v46, v49, v6
    v_and_b32 v47, v49, v7
    s_waitcnt vmcnt(6)
    s_nop 0
    v_mfma_f32_16x16x32_bf16 v[52:55], v[44:47], v[100:103], v[52:55]
    v_perm_b32 v48, v37, v37, s60
    v_and_b32 v40, v48, v4
    v_and_b32 v41, v48, v5
    v_and_b32 v42, v48, v6
    v_and_b32 v43, v48, v7
    s_waitcnt vmcnt(5)
    s_nop 0
    v_mfma_f32_16x16x32_bf16 v[52:55], v[40:43], v[104:107], v[52:55]
    v_perm_b32 v49, v37, v37, s61
    v_and_b32 v44, v49, v4
    v_and_b32 v45, v49, v5
    v_and_b32 v46, v49, v6
    v_and_b32 v47, v49, v7
    s_waitcnt vmcnt(4)
    s_nop 0
    v_mfma_f32_16x16x32_bf16 v[52:55], v[44:47], v[108:111], v[52:55]
    v_perm_b32 v48, v38, v38, s60
    v_and_b32 v40, v48, v4
    v_and_b32 v41, v48, v5
    v_and_b32 v42, v48, v6
    v_and_b32 v43, v48, v7
    s_waitcnt vmcnt(3)
    s_nop 0
    v_mfma_f32_16x16x32_bf16 v[52:55], v[40:43], v[112:115], v[52:55]
    v_perm_b32 v49, v38, v38, s61
    v_and_b32 v44, v49, v4
    v_and_b32 v45, v49, v5
    v_and_b32 v46, v49, v6
    v_and_b32 v47, v49, v7
    s_waitcnt vmcnt(2)
    s_nop 0
    v_mfma_f32_16x16x32_bf16 v[52:55], v[44:47], v[116:119], v[52:55]
    v_perm_b32 v48, v39, v39, s60
    v_and_b32 v40, v48, v4
    v_and_b32 v41, v48, v5
    v_and_b32 v42, v48, v6
    v_and_b32 v43, v48, v7
    s_waitcnt vmcnt(1)
    s_nop 0
    v_mfma_f32_16x16x32_bf16 v[52:55], v[40:43], v[120:123], v[52:55]
    v_perm_b32 v49, v39, v39, s61
    v_and_b32 v44, v49, v4
    v_and_b32 v45, v49, v5
    v_and_b32 v46, v49, v6
    v_and_b32 v47, v49, v7
    s_waitcnt vmcnt(0)
    s_nop 0
    v_mfma_f32_16x16x32_bf16 v[52:55], v[44:47], v[124:127], v[52:55]
    s_lshl_b32 s52, s34, 10
    s_lshl_b32 s44, s4, 13
    s_add_u32 s45, s44, 4096
    v_cmp_lt_u32 vcc, 31, v1
    s_nop 3
    v_cndmask_b32 v52, v52, v54, vcc
    v_cndmask_b32 v53, v53, v55, vcc
    v_mov_b32 v54, s62
    v_mov_b32 v55, s80
    buffer_store_dwordx4 v[52:55], v50, s[36:39], s52 offen
    s_mov_b32 s51, 0x200000
L_sp_9:
    ds_read_b32 v10, v2 offset:16
    s_waitcnt lgkmcnt(0)
    v_readfirstlane_b32 s48, v10
    s_nop 1
    s_cmp_ge_u32 s48, 1
    s_cbranch_scc1 L_spd_10
    s_sleep 4
    s_sub_u32 s51, s51, 1
    s_cbranch_scc0 L_sp_9
    s_endpgm
L_spd_10:
    s_mov_b32 s50, 0x40000
    s_movk_i32 s51, 24
L_qp:
    buffer_load_dwordx4 v[64:67], v3, s[36:39], s44 offen offset:0 sc1
    buffer_load_dwordx4 v[68:71], v3, s[36:39], s44 offen offset:1024 sc1
    buffer_load_dwordx4 v[72:75], v3, s[36:39], s44 offen offset:2048 sc1
    buffer_load_dwordx4 v[76:79], v3, s[36:39], s44 offen offset:3072 sc1
    buffer_load_dwordx4 v[80:83], v3, s[36:39], s45 offen offset:0 sc1
    buffer_load_dwordx4 v[84:87], v3, s[36:39], s45 offen offset:1024 sc1
    buffer_load_dwordx4 v[88:91], v3, s[36:39], s45 offen offset:2048 sc1
    buffer_load_dwordx4 v[92:95], v3, s[36:39], s45 offen offset:3072 sc1
    s_waitcnt vmcnt(0)
    v_xor_b32 v66, s62, v66
    v_xor_b32 v11, s80, v67
    v_xor_b32 v67, s81, v67
    v_min_u32 v11, v11, v67
    v_or_b32 v10, v66, v11
    v_xor_b32 v70, s62, v70
    v_xor_b32 v11, s80, v71
    v_xor_b32 v71, s81, v71
    v_min_u32 v11, v11, v71
    v_or3_b32 v10, v10, v70, v11
    v_xor_b32 v74, s62, v74
    v_xor_b32 v11, s80, v75
    v_xor_b32 v75, s81, v75
    v_min_u32 v11, v11, v75
    v_or3_b32 v10, v10, v74, v11
    v_xor_b32 v78, s62, v78
    v_xor_b32 v11, s80, v79
    v_xor_b32 v79, s81, v79
    v_min_u32 v11, v11, v79
    v_or3_b32 v10, v10, v78, v11
    v_xor_b32 v82, s62, v82
    v_xor_b32 v11, s80, v83
    v_xor_b32 v83, s81, v83
    v_min_u32 v11, v11, v83
    v_or3_b32 v10, v10, v82, v11
    v_xor_b32 v86, s62, v86
    v_xor_b32 v11, s80, v87
    v_xor_b32 v87, s81, v87
    v_min_u32 v11, v11, v87
    v_or3_b32 v10, v10, v86, v11
    v_xor_b32 v90, s62, v90
    v_xor_b32 v11, s80, v91
    v_xor_b32 v91, s81, v91
    v_min_u32 v11, v11, v91
    v_or3_b32 v10, v10, v90, v11
    v_xor_b32 v94, s62, v94
    v_xor_b32 v11, s80, v95
    v_xor_b32 v95, s81, v95
    v_min_u32 v11, v11, v95
    v_or3_b32 v10, v10, v94, v11
L_hop5:
    s_cbranch_execz L_warmret
    v_cmp_ne_u32 vcc, 0, v10
    s_nop 1
    s_cbranch_vccz L_qc
    s_sub_u32 s50, s50, 1
    s_cbranch_scc1 L_end
    s_sub_u32 s51, s51, 1
    s_cbranch_scc0 L_qp
L_qs:
    s_mov_b32 s51, 0x7fffffff
    s_mov_b32 s82, 1
    s_add_u32 s48, s6, 393216
    s_mov_b32 exec_hi, 0
    buffer_store_dwordx4 v[56:59], v3, s[36:39], s48 offen sc1
    s_mov_b32 exec_hi, -1
    s_waitcnt vmcnt(0)
    v_mov_b32 v55, s81
    buffer_store_dwordx4 v[52:55], v50, s[36:39], s52 offen sc1
    s_branch L_qp
L_qc:
    s_cmp_lg_u32 s82, 0
    s_cbranch_scc1 L_qd
    v_min3_u32 v11, v67, v71, v75
    v_min3_u32 v11, v11, v79, v83
    v_min3_u32 v11, v11, v87, v91
    v_min_u32 v11, v11, v95
    v_cmp_eq_u32 vcc, 0, v11
    s_nop 1
    s_cbranch_vccnz L_qs
L_qd:
    v_add_f32 v64, v64, v68
    v_add_f32 v65, v65, v69
    v_add_f32 v64, v64, v72
    v_add_f32 v65, v65, v73
    v_add_f32 v64, v64, v76
    v_add_f32 v65, v65, v77
    v_add_f32 v64, v64, v80
    v_add_f32 v65, v65, v81
    v_add_f32 v64, v64, v84
    v_add_f32 v65, v65, v85
    v_add_f32 v64, v64, v88
    v_add_f32 v65, v65, v89
    v_add_f32 v64, v64, v92
    v_add_f32 v65, v65, v93
    v_cvt_pk_bf16_f32 v64, v64, v65
    v_lshlrev_b32 v10, 2, v1
    v_mov_b32 v11, 1
    ds_write_b32 v10, v64 offset:128
    v_mov_b32 v68, s62
    v_mov_b32 v69, s63
    v_mov_b32 v70, s82
    ds_write_b128 v2, v[68:71] offset:48
    ds_write_b32 v2, v11 offset:0
    s_branch L_Hc
L_H1b:
    s_load_dwordx2 s[62:63], s[32:33], 819200
    s_mov_b32 s36, s32
    s_mov_b32 s37, s33
    s_mov_b32 s38, 0x100000
    s_mov_b32 s39, 0x20000
    s_mov_b32 s60, 0x01000100
    s_mov_b32 s61, 0x03020302
    v_mov_b32 v2, 0
    v_and_b32 v10, 1, v1
    v_lshlrev_b32 v10, 4, v10
    v_mov_b32 v11, 0xffff
    v_lshlrev_b32 v11, v10, v11
    v_bfe_u32 v10, v1, 1, 2
    v_cmp_eq_u32 vcc, 0, v10
    s_nop 1
    v_cndmask_b32 v4, 0, v11, vcc
    v_cmp_eq_u32 vcc, 1, v10
    s_nop 1
    v_cndmask_b32 v5, 0, v11, vcc
    v_cmp_eq_u32 vcc, 2, v10
    s_nop 1
    v_cndmask_b32 v6, 0, v11, vcc
    v_cmp_eq_u32 vcc, 3, v10
    s_nop 1
    v_cndmask_b32 v7, 0, v11, vcc
    v_and_b32 v50, 1, v8
    v_lshlrev_b32 v50, 5, v50
    v_lshl_or_b32 v50, v9, 6, v50
    v_lshrrev_b32 v11, 1, v8
    v_lshl_or_b32 v50, v11, 4, v50
    s_mov_b32 s53, 2
    s_not_b64 exec, s[58:59]
    v_mov_b32 v96, 0
    v_mov_b32 v97, 0
    v_mov_b32 v98, 0
    v_mov_b32 v99, 0
    v_mov_b32 v100, 0
    v_mov_b32 v101, 0
    v_mov_b32 v102, 0
    v_mov_b32 v103, 0
    v_mov_b32 v104, 0
    v_mov_b32 v105, 0
    v_mov_b32 v106, 0
    v_mov_b32 v107, 0
    v_mov_b32 v108, 0
    v_mov_b32 v109, 0
    v_mov_b32 v110, 0
    v_mov_b32 v111, 0
    v_mov_b32 v112, 0
    v_mov_b32 v113, 0
    v_mov_b32 v114, 0
    v_mov_b32 v115, 0
    v_mov_b32 v116, 0
    v_mov_b32 v117, 0
    v_mov_b32 v118, 0
    v_mov_b32 v119, 0
    v_mov_b32 v120, 0
    v_mov_b32 v121, 0
    v_mov_b32 v122, 0
    v_mov_b32 v123, 0
    v_mov_b32 v124, 0
    v_mov_b32 v125, 0
    v_mov_b32 v126, 0
    v_mov_b32 v127, 0
    s_mov_b64 exec, -1
    s_waitcnt vmcnt(17)
L_ln2:
    v_lshlrev_b32 v16, 16, v12
    v_and_b32 v17, 0xffff0000, v12
    v_lshlrev_b32 v18, 16, v13
    v_and_b32 v19, 0xffff0000, v13
    v_lshlrev_b32 v20, 16, v14
    v_and_b32 v21, 0xffff0000, v14
    v_lshlrev_b32 v22, 16, v15
    v_and_b32 v23, 0xffff0000, v15
    v_add_f32 v24, v16, v17
    v_add_f32 v25, v18, v19
    v_add_f32 v26, v20, v21
    v_add_f32 v27, v22, v23
    v_add_f32 v24, v24, v25
    v_add_f32 v26, v26, v27
    v_add_f32 v24, v24, v26
    s_nop 1
    v_add_f32_dpp v24, v24, v24 row_ror:8 row_mask:0xf bank_mask:0xf
    s_nop 1
    v_add_f32_dpp v24, v24, v24 row_ror:4 row_mask:0xf bank_mask:0xf
    s_nop 1
    v_add_f32_dpp v24, v24, v24 row_ror:2 row_mask:0xf bank_mask:0xf
    s_nop 1
    v_add_f32_dpp v24, v24, v24 row_ror:1 row_mask:0xf bank_mask:0xf
    v_mov_b32 v28, v24
    s_nop 1
    v_permlane16_swap_b32 v24, v28
    v_add_f32 v24, v24, v28
    v_mov_b32 v28, v24
    s_nop 1
    v_permlane32_swap_b32 v24, v28
    v_add_f32 v24, v24, v28
    v_mul_f32 v24, 0x3b000000, v24
    v_sub_f32 v26, v16, v24
    v_mul_f32 v25, v26, v26
    v_sub_f32 v27, v17, v24
    v_fmac_f32 v25, v27, v27
    v_sub_f32 v26, v18, v24
    v_fmac_f32 v25, v26, v26
    v_sub_f32 v27, v19, v24
    v_fmac_f32 v25, v27, v27
    v_sub_f32 v26, v20, v24
    v_fmac_f32 v25, v26, v26
    v_sub_f32 v27, v21, v24
    v_fmac_f32 v25, v27, v27
    v_sub_f32 v26, v22, v24
    v_fmac_f32 v25, v26, v26
    v_sub_f32 v27, v23, v24
    v_fmac_f32 v25, v27, v27
    s_nop 1
    v_add_f32_dpp v25, v25, v25 row_ror:8 row_mask:0xf bank_mask:0xf
    s_nop 1
    v_add_f32_dpp v25, v25, v25 row_ror:4 row_mask:0xf bank_mask:0xf
    s_nop 1
    v_add_f32_dpp v25, v25, v25 row_ror:2 row_mask:0xf bank_mask:0xf
    s_nop 1
    v_add_f32_dpp v25, v25, v25 row_ror:1 row_mask:0xf bank_mask:0xf
    v_mov_b32 v28, v25
    s_nop 1
    v_permlane16_swap_b32 v25, v28
    v_add_f32 v25, v25, v28
    v_mov_b32 v28, v25
    s_nop 1
    v_permlane32_swap_b32 v25, v28
    v_add_f32 v25, v25, v28
    v_mul_f32 v25, 0x3b000000, v25
    v_cvt_pk_bf16_f32 v26, v24, v25
    v_lshlrev_b32 v24, 16, v26
    v_and_b32 v25, 0xffff0000, v26
    v_add_f32 v25, 0x3727c5ac, v25
    v_cvt_pk_bf16_f32 v25, v25, v25
    v_and_b32 v25, 0xffff0000, v25
    v_sqrt_f32 v25, v25
    s_nop 0
    v_cvt_pk_bf16_f32 v25, v25, v25
    v_and_b32 v25, 0xffff0000, v25
    v_rcp_f32 v27, v25
    v_sub_f32 v16, v16, v24
    v_sub_f32 v17, v17, v24
    v_sub_f32 v18, v18, v24
    v_sub_f32 v19, v19, v24
    v_sub_f32 v20, v20, v24
    v_sub_f32 v21, v21, v24
    v_sub_f32 v22, v22, v24
    v_sub_f32 v23, v23, v24
    v_cvt_pk_bf16_f32 v12, v16, v17
    v_cvt_pk_bf16_f32 v13, v18, v19
    v_cvt_pk_bf16_f32 v14, v20, v21
    v_cvt_pk_bf16_f32 v15, v22, v23
    v_lshlrev_b32 v16, 16, v12
    v_and_b32 v17, 0xffff0000, v12
    v_lshlrev_b32 v18, 16, v13
    v_and_b32 v19, 0xffff0000, v13
    v_lshlrev_b32 v20, 16, v14
    v_and_b32 v21, 0xffff0000, v14
    v_lshlrev_b32 v22, 16, v15
    v_and_b32 v23, 0xffff0000, v15
    v_mul_f32 v28, v16, v27
    v_fma_f32 v16, -v28, v25, v16
    v_fma_f32 v28, v16, v27, v28
    v_mul_f32 v29, v17, v27
L_hop6:
    s_cbranch_execz L_warmret
    v_fma_f32 v17, -v29, v25, v17
    v_fma_f32 v29, v17, v27, v29
    v_cvt_pk_bf16_f32 v12, v28, v29
    v_mul_f32 v28, v18, v27
    v_fma_f32 v18, -v28, v25, v18
    v_fma_f32 v28, v18, v27, v28
    v_mul_f32 v29, v19, v27
    v_fma_f32 v19, -v29, v25, v19
    v_fma_f32 v29, v19, v27, v29
    v_cvt_pk_bf16_f32 v13, v28, v29
    v_mul_f32 v28, v20, v27
    v_fma_f32 v20, -v28, v25, v20
    v_fma_f32 v28, v20, v27, v28
    v_mul_f32 v29, v21, v27
    v_fma_f32 v21, -v29, v25, v21
    v_fma_f32 v29, v21, v27, v29
    v_cvt_pk_bf16_f32 v14, v28, v29
    v_mul_f32 v28, v22, v27
    v_fma_f32 v22, -v28, v25, v22
    v_fma_f32 v28, v22, v27, v28
    v_mul_f32 v29, v23, v27
    v_fma_f32 v23, -v29, v25, v23
    v_fma_f32 v29, v23, v27, v29
    v_cvt_pk_bf16_f32 v15, v28, v29
    s_sub_u32 s53, s53, 1
    s_cmp_lg_u32 s53, 0
    s_cbranch_scc1 L_ln2
    ds_write_b128 v3, v[12:15] offset:1536
    s_lshl_b32 s48, s5, 7
    v_add_u32 v10, s48, v62
    ds_read_b128 v[32:35], v10 offset:1536
    s_waitcnt vmcnt(9) lgkmcnt(0)
    s_mul_i32 s62, s62, 0x9e3779b1
    s_add_u32 s62, s62, 0x7f4a7c15
    s_mul_i32 s63, s63, 0x85ebca6d
    s_add_u32 s63, s63, 0xc2b2ae35
    s_getreg_b32 s80, hwreg(HW_REG_XCC_ID)
    s_and_b32 s80, s80, 0xff
    s_xor_b32 s80, s80, s63
    s_xor_b32 s81, s63, 0x100
    s_mov_b32 s82, 0
    s_add_u32 s52, s6, 262144
    v_perm_b32 v48, v32, v32, s60
    v_and_b32 v40, v48, v4
    v_and_b32 v41, v48, v5
    v_and_b32 v42, v48, v6
    v_and_b32 v43, v48, v7
    s_nop 1
    v_mfma_f32_16x16x32_bf16 v[52:55], v[40:43], v[64:67], 0
    v_perm_b32 v49, v32, v32, s61
    v_and_b32 v44, v49, v4
    v_and_b32 v45, v49, v5
    v_and_b32 v46, v49, v6
    v_and_b32 v47, v49, v7
    s_nop 1
    v_mfma_f32_16x16x32_bf16 v[52:55], v[44:47], v[68:71], v[52:55]
    v_perm_b32 v48, v33, v33, s60
    v_and_b32 v40, v48, v4
    v_and_b32 v41, v48, v5
    v_and_b32 v42, v48, v6
    v_and_b32 v43, v48, v7
    s_nop 1
    v_mfma_f32_16x16x32_bf16 v[52:55], v[40:43], v[72:75], v[52:55]
    v_perm_b32 v49, v33, v33, s61
    v_and_b32 v44, v49, v4
    v_and_b32 v45, v49, v5
    v_and_b32 v46, v49, v6
    v_and_b32 v47, v49, v7
    s_nop 1
    v_mfma_f32_16x16x32_bf16 v[52:55], v[44:47], v[76:79], v[52:55]
    v_perm_b32 v48, v34, v34, s60
    v_and_b32 v40, v48, v4
    v_and_b32 v41, v48, v5
    v_and_b32 v42, v48, v6
    v_and_b32 v43, v48, v7
    s_nop 1
    v_mfma_f32_16x16x32_bf16 v[52:55], v[40:43], v[80:83], v[52:55]
    v_perm_b32 v49, v34, v34, s61
    v_and_b32 v44, v49, v4
    v_and_b32 v45, v49, v5
    v_and_b32 v46, v49, v6
    v_and_b32 v47, v49, v7
    s_nop 1
    v_mfma_f32_16x16x32_bf16 v[52:55], v[44:47], v[84:87], v[52:55]
    v_perm_b32 v48, v35, v35, s60
    v_and_b32 v40, v48, v4
    v_and_b32 v41, v48, v5
    v_and_b32 v42, v48, v6
    v_and_b32 v43, v48, v7
    s_nop 1
    v_mfma_f32_16x16x32_bf16 v[52:55], v[40:43], v[88:91], v[52:55]
    v_perm_b32 v49, v35, v35, s61
    v_and_b32 v44, v49, v4
    v_and_b32 v45, v49, v5
    v_and_b32 v46, v49, v6
    v_and_b32 v47, v49, v7
    s_nop 1
    v_mfma_f32_16x16x32_bf16 v[52:55], v[44:47], v[92:95], v[52:55]
    s_nop 7
    v_mov_b32 v40, v52
    v_mov_b32 v41, v53
    v_mov_b32 v42, v54
    v_mov_b32 v43, v55
    v_permlane32_swap_b32 v52, v40
    v_permlane32_swap_b32 v53, v41
    v_permlane32_swap_b32 v54, v42
    v_permlane32_swap_b32 v55, v43
    v_add_f32_dpp v52, v40, v52 row_ror:8 row_mask:0xf bank_mask:0xf
    v_add_f32_dpp v53, v41, v53 row_ror:8 row_mask:0xf bank_mask:0xf
    v_add_f32_dpp v54, v42, v54 row_ror:8 row_mask:0xf bank_mask:0xf
    v_add_f32_dpp v55, v43, v55 row_ror:8 row_mask:0xf bank_mask:0xf
    s_lshl_b32 s44, s4, 12
    s_add_u32 s44, s44, 262144
    v_lshrrev_b32 v60, 1, v1
    v_lshlrev_b32 v60, 4, v60
    v_cmp_lt_u32 vcc, 31, v1
    s_nop 1
    v_cndmask_b32 v52, v52, v54, vcc
    v_cndmask_b32 v53, v53, v55, vcc
    v_mov_b32 v54, s62
    v_mov_b32 v55, s80
    s_mov_b32 exec_lo, 0x00ff00ff
    s_mov_b32 exec_hi, 0x00ff00ff
    buffer_store_dwordx4 v[52:55], v50, s[36:39], s52 offen
    s_mov_b64 exec, -1
    s_mov_b32 s51, 0x200000
L_sp_11:
    ds_read_b32 v10, v2 offset:16
    s_waitcnt lgkmcnt(0)
    v_readfirstlane_b32 s48, v10
    s_nop 1
    s_cmp_ge_u32 s48, 1
    s_cbranch_scc1 L_spd_12
    s_sleep 4
    s_sub_u32 s51, s51, 1
    s_cbranch_scc0 L_sp_11
    s_endpgm
L_spd_12:
    s_mov_b32 s50, 0x40000
    s_movk_i32 s51, 24
L_zp:
    buffer_load_dwordx4 v[64:67], v60, s[36:39], s44 offen offset:0 sc1
    buffer_load_dwordx4 v[68:71], v60, s[36:39], s44 offen offset:512 sc1
    buffer_load_dwordx4 v[72:75], v60, s[36:39], s44 offen offset:1024 sc1
    buffer_load_dwordx4 v[76:79], v60, s[36:39], s44 offen offset:1536 sc1
    buffer_load_dwordx4 v[80:83], v60, s[36:39], s44 offen offset:2048 sc1
    buffer_load_dwordx4 v[84:87], v60, s[36:39], s44 offen offset:2560 sc1
    buffer_load_dwordx4 v[88:91], v60, s[36:39], s44 offen offset:3072 sc1
    buffer_load_dwordx4 v[92:95], v60, s[36:39], s44 offen offset:3584 sc1
    s_waitcnt vmcnt(0)
    v_xor_b32 v66, s62, v66
    v_xor_b32 v11, s80, v67
    v_xor_b32 v67, s81, v67
    v_min_u32 v11, v11, v67
    v_or_b32 v10, v66, v11
    v_xor_b32 v70, s62, v70
    v_xor_b32 v11, s80, v71
    v_xor_b32 v71, s81, v71
    v_min_u32 v11, v11, v71
    v_or3_b32 v10, v10, v70, v11
    v_xor_b32 v74, s62, v74
    v_xor_b32 v11, s80, v75
    v_xor_b32 v75, s81, v75
    v_min_u32 v11, v11, v75
    v_or3_b32 v10, v10, v74, v11
    v_xor_b32 v78, s62, v78
    v_xor_b32 v11, s80, v79
    v_xor_b32 v79, s81, v79
    v_min_u32 v11, v11, v79
    v_or3_b32 v10, v10, v78, v11
    v_xor_b32 v82, s62, v82
    v_xor_b32 v11, s80, v83
    v_xor_b32 v83, s81, v83
    v_min_u32 v11, v11, v83
    v_or3_b32 v10, v10, v82, v11
    v_xor_b32 v86, s62, v86
    v_xor_b32 v11, s80, v87
    v_xor_b32 v87, s81, v87
    v_min_u32 v11, v11, v87
    v_or3_b32 v10, v10, v86, v11
    v_xor_b32 v90, s62, v90
    v_xor_b32 v11, s80, v91
    v_xor_b32 v91, s81, v91
    v_min_u32 v11, v11, v91
    v_or3_b32 v10, v10, v90, v11
    v_xor_b32 v94, s62, v94
    v_xor_b32 v11, s80, v95
    v_xor_b32 v95, s81, v95
    v_min_u32 v11, v11, v95
    v_or3_b32 v10, v10, v94, v11
L_hop7:
    s_cbranch_execz L_warmret
    v_cmp_ne_u32 vcc, 0, v10
    s_nop 1
    s_cbranch_vccz L_zc
    s_sub_u32 s50, s50, 1
    s_cbranch_scc1 L_end
    s_sub_u32 s51, s51, 1
    s_cbranch_scc0 L_zp
L_zs:
    s_mov_b32 s51, 0x7fffffff
    s_mov_b32 s82, 1
    v_mov_b32 v55, s81
    s_mov_b32 exec_lo, 0x00ff00ff
    s_mov_b32 exec_hi, 0x00ff00ff
    buffer_store_dwordx4 v[52:55], v50, s[36:39], s52 offen sc1
    s_mov_b64 exec, -1
    s_branch L_zp
L_zc:
    s_cmp_lg_u32 s82, 0
    s_cbranch_scc1 L_zd
    v_min3_u32 v11, v67, v71, v75
    v_min3_u32 v11, v11, v79, v83
    v_min3_u32 v11, v11, v87, v91
    v_min_u32 v11, v11, v95
    v_cmp_eq_u32 vcc, 0, v11
    s_nop 1
    s_cbranch_vccnz L_zs
L_zd:
    v_add_f32 v64, v64, v68
    v_add_f32 v65, v65, v69
    v_add_f32 v64, v64, v72
    v_add_f32 v65, v65, v73
    v_add_f32 v64, v64, v76
    v_add_f32 v65, v65, v77
    v_add_f32 v64, v64, v80
    v_add_f32 v65, v65, v81
    v_add_f32 v64, v64, v84
    v_add_f32 v65, v65, v85
    v_add_f32 v64, v64, v88
    v_add_f32 v65, v65, v89
    v_add_f32 v64, v64, v92
    v_add_f32 v65, v65, v93
    v_and_b32 v10, 1, v1
    v_cmp_eq_u32 vcc, 1, v10
    s_nop 1
    v_cndmask_b32 v16, v64, v65, vcc
    v_cvt_pk_bf16_f32 v16, v16, v16
    v_and_b32 v16, 0xffff0000, v16
    v_lshlrev_b32 v63, 16, v63
    v_add_f32 v16, v16, v63
    v_cvt_pk_bf16_f32 v16, v16, v16
    v_and_b32 v16, 0xffff0000, v16
    v_mul_f32 v17, v16, v16
    v_mul_f32 v17, v17, v16
    v_mov_b32 v18, 0x3d372713
    v_fma_f32 v17, v18, v17, v16
    v_mul_f32 v17, 0xc0135761, v17
    v_exp_f32 v17, v17
    s_nop 0
    v_add_f32 v17, 1.0, v17
    v_rcp_f32 v17, v17
    s_nop 0
    v_mul_f32 v16, v16, v17
    v_cvt_pk_bf16_f32 v16, v16, v16
    v_cndmask_b32 v16, 0, v16, s[58:59]
    v_lshlrev_b32 v10, 1, v1
    ds_write_b16 v10, v16 offset:384
    ds_read_b128 v[32:35], v62 offset:384
    s_waitcnt lgkmcnt(0)
    v_perm_b32 v48, v32, v32, s60
    v_and_b32 v40, v48, v4
    v_and_b32 v41, v48, v5
    v_and_b32 v42, v48, v6
    v_and_b32 v43, v48, v7
    s_nop 1
    v_mfma_f32_16x16x32_bf16 v[52:55], v[40:43], v[96:99], 0
    v_perm_b32 v49, v32, v32, s61
    v_and_b32 v44, v49, v4
    v_and_b32 v45, v49, v5
    v_and_b32 v46, v49, v6
    v_and_b32 v47, v49, v7
    s_nop 1
    v_mfma_f32_16x16x32_bf16 v[52:55], v[44:47], v[100:103], v[52:55]
    v_perm_b32 v48, v33, v33, s60
    v_and_b32 v40, v48, v4
    v_and_b32 v41, v48, v5
    v_and_b32 v42, v48, v6
    v_and_b32 v43, v48, v7
    s_nop 1
    v_mfma_f32_16x16x32_bf16 v[52:55], v[40:43], v[104:107], v[52:55]
    v_perm_b32 v49, v33, v33, s61
    v_and_b32 v44, v49, v4
    v_and_b32 v45, v49, v5
    v_and_b32 v46, v49, v6
    v_and_b32 v47, v49, v7
    s_nop 1
    v_mfma_f32_16x16x32_bf16 v[52:55], v[44:47], v[108:111], v[52:55]
    v_perm_b32 v48, v34, v34, s60
    v_and_b32 v40, v48, v4
    v_and_b32 v41, v48, v5
    v_and_b32 v42, v48, v6
    v_and_b32 v43, v48, v7
    s_nop 1
    v_mfma_f32_16x16x32_bf16 v[52:55], v[40:43], v[112:115], v[52:55]
    v_perm_b32 v49, v34, v34, s61
    v_and_b32 v44, v49, v4
    v_and_b32 v45, v49, v5
    v_and_b32 v46, v49, v6
    v_and_b32 v47, v49, v7
    s_nop 1
    v_mfma_f32_16x16x32_bf16 v[52:55], v[44:47], v[116:119], v[52:55]
    v_perm_b32 v48, v35, v35, s60
    v_and_b32 v40, v48, v4
    v_and_b32 v41, v48, v5
    v_and_b32 v42, v48, v6
    v_and_b32 v43, v48, v7
    s_nop 1
    v_mfma_f32_16x16x32_bf16 v[52:55], v[40:43], v[120:123], v[52:55]
    v_perm_b32 v49, v35, v35, s61
    v_and_b32 v44, v49, v4
    v_and_b32 v45, v49, v5
    v_and_b32 v46, v49, v6
    v_and_b32 v47, v49, v7
    s_nop 1
    v_mfma_f32_16x16x32_bf16 v[52:55], v[44:47], v[124:127], v[52:55]
    s_nop 7
    v_mov_b32 v40, v52
    v_mov_b32 v41, v53
    v_mov_b32 v42, v54
    v_mov_b32 v43, v55
    v_permlane32_swap_b32 v52, v40
    v_permlane32_swap_b32 v53, v41
    v_permlane32_swap_b32 v54, v42
    v_permlane32_swap_b32 v55, v43
    v_add_f32_dpp v52, v40, v52 row_ror:8 row_mask:0xf bank_mask:0xf
    v_add_f32_dpp v53, v41, v53 row_ror:8 row_mask:0xf bank_mask:0xf
    v_add_f32_dpp v54, v42, v54 row_ror:8 row_mask:0xf bank_mask:0xf
    v_add_f32_dpp v55, v43, v55 row_ror:8 row_mask:0xf bank_mask:0xf
    v_lshlrev_b32 v10, 5, v9
    v_lshl_or_b32 v10, v8, 4, v10
    s_mov_b64 exec, 0x00ff00ff
    ds_write_b128 v10, v[52:55] offset:3584
    s_mov_b64 exec, -1
    s_branch L_Hc
L_H3:
    v_mov_b32 v2, 0
    s_mov_b32 s50, 0x200000
L_sp_13:
    ds_read_b32 v11, v2 offset:16
    s_waitcnt lgkmcnt(0)
    v_readfirstlane_b32 s48, v11
    s_nop 1
    s_cmp_ge_u32 s48, 1
    s_cbranch_scc1 L_spd_14
    s_sleep 4
    s_sub_u32 s50, s50, 1
    s_cbranch_scc0 L_sp_13
    s_endpgm
L_spd_14:
    s_lshl_b32 s48, s34, 2
    v_and_b32 v60, 1, v8
    v_lshl_add_u32 v60, v60, 1, s48
    s_mov_b32 exec_lo, 0x55555555
    s_mov_b32 exec_hi, 0x55555555
    global_load_ushort v61, v60, s[8:9]
    s_mov_b32 exec_lo, 0xaaaaaaaa
    s_mov_b32 exec_hi, 0xaaaaaaaa
    global_load_ushort v61, v60, s[26:27]
    s_mov_b64 exec, -1
L_Hc0:
    s_mov_b32 s36, s32
    s_mov_b32 s37, s33
    s_mov_b32 s38, 0x100000
    s_mov_b32 s39, 0x20000
    v_mov_b32 v2, 0
L_Hc:
    s_lshl_b32 s48, s4, 2
    s_add_u32 s48, s48, s3
    s_lshl_b32 s48, s48, 15
    s_lshl_b32 s49, s5, 7
    s_add_u32 s48, s48, s49
    s_add_u32 s40, s16, s48
    s_addc_u32 s41, s17, 0
    s_sub_u32 s42, 4194304, s48
    s_mov_b32 s43, 0x20000
    v_lshrrev_b32 v10, 3, v1
    v_and_b32 v11, 7, v1
    v_lshlrev_b32 v11, 4, v11
    v_lshl_or_b32 v12, v10, 10, v11
    s_movk_i32 s49, 144
    v_mad_u32_u24 v13, v10, s49, v11
    s_mul_i32 s48, s3, 4608
    v_add_u32 v13, s48, v13
    v_bfe_u32 v10, v1, 2, 2
    v_lshl_add_u32 v10, v8, 3, v10
    v_and_b32 v11, 3, v1
    v_lshlrev_b32 v11, 3, v11
    v_mad_u32_u24 v14, v10, s49, v11
    v_add_u32 v14, s48, v14
    v_and_b32 v10, 7, v1
    v_lshlrev_b32 v15, 7, v10
    v_lshlrev_b32 v16, 9, v10
    v_lshrrev_b32 v10, 3, v9
    v_lshl_or_b32 v16, v10, 8, v16
L_hop8:
    s_cbranch_execz L_warmret
    v_lshl_or_b32 v16, v8, 4, v16
    s_lshl_b32 s44, s4, 12
    s_add_u32 s44, s44, 393216
    s_lshl_b32 s45, s4, 10
    s_add_u32 s45, s45, 786432
    s_lshl_b32 s55, s34, 10
    s_add_u32 s55, s55, 524288
    s_lshl_b32 s48, s3, 6
    v_add_u32 v16, s48, v16
    s_lshl_b32 s48, s3, 8
    v_lshl_add_u32 v56, v1, 2, s48
    v_lshrrev_b32 v58, 1, v1
    v_lshlrev_b32 v58, 3, v58
    v_lshlrev_b32 v59, 4, v1
    v_mov_b32 v22, 0
    v_mov_b32 v23, 0
    v_mov_b32 v24, 0
    v_mov_b32 v25, 0
    v_mov_b32 v26, 0
    v_mov_b32 v27, 0
    v_lshrrev_b32 v57, 1, v1
    v_lshlrev_b32 v57, 13, v57
    v_and_b32 v11, 1, v1
    v_lshl_or_b32 v57, v11, 4, v57
    v_mul_u32_u24 v18, 1024, v11
    v_add_u32 v18, v18, v58
    s_lshr_b32 s54, s34, 5
    s_lshl_b32 s59, s54, 12
    s_lshl_b32 s54, s54, 10
    s_and_b32 s49, s34, 31
    s_lshl_b32 s49, s49, 5
    s_add_u32 s54, s54, s49
    s_add_u32 s54, s54, 524288
    s_lshl_b32 s48, s34, 2
    v_and_b32 v60, 1, v8
    v_lshl_add_u32 v60, v60, 1, s48
    v_lshlrev_b32 v19, 12, v1
    s_lshl_b32 s58, s4, 7
    s_add_u32 s58, s58, 851968
    v_lshlrev_b32 v28, 7, v1
    s_add_u32 s59, s59, 851968
    s_or_b32 s83, s3, s5
    s_cmp_lg_u32 s3, 3
    s_cbranch_scc1 L_nfw
    s_mov_b32 exec_hi, 0
    buffer_load_dwordx2 v[30:31], v28, s[36:39], s59 offen sc1
    s_mov_b32 exec_hi, -1
L_nfw:
    s_mov_b32 s50, 0x200000
L_sp_15:
    ds_read_b32 v10, v2 offset:0
    s_waitcnt lgkmcnt(0)
    v_readfirstlane_b32 s48, v10
    s_nop 1
    s_cmp_eq_u32 s48, 1
    s_cbranch_scc1 L_spd_16
    s_sleep 2
    s_sub_u32 s50, s50, 1
    s_cbranch_scc0 L_sp_15
    s_endpgm
L_spd_16:
    ds_read_b128 v[84:87], v2 offset:48
    s_waitcnt lgkmcnt(0)
    v_readfirstlane_b32 s62, v84
    v_readfirstlane_b32 s63, v85
    v_readfirstlane_b32 s82, v86
    v_mov_b32 v32, s62
    v_mov_b32 v33, s63
    s_mov_b32 s50, 0x200000
L_sp_17:
    ds_read_b32 v11, v2 offset:32
    s_waitcnt lgkmcnt(0)
    v_readfirstlane_b32 s48, v11
    s_nop 1
    s_cmp_ge_u32 s48, 6
    s_cbranch_scc1 L_spd_18
    s_sleep 1
    s_sub_u32 s50, s50, 1
    s_cbranch_scc0 L_sp_17
    s_endpgm
L_spd_18:
    s_mov_b32 s49, 0
    s_mov_b32 s50, 0x40000
    buffer_load_dwordx4 v[128:131], v12, s[40:43], s49 offen nt
    s_addk_i32 s49, 0x2000
    buffer_load_dwordx4 v[132:135], v12, s[40:43], s49 offen nt
    s_addk_i32 s49, 0x2000
    buffer_load_dwordx4 v[136:139], v12, s[40:43], s49 offen nt
    s_addk_i32 s49, 0x2000
    buffer_load_dwordx4 v[140:143], v12, s[40:43], s49 offen nt
    buffer_load_dwordx4 v[96:99], v15, s[36:39], s45 offen sc1
    s_waitcnt vmcnt(1)
    buffer_load_dwordx4 v[80:83], v16, s[36:39], s44 offen sc1
    ds_write_b128 v13, v[128:131] offset:8192
    ds_write_b128 v13, v[132:135] offset:9344
    ds_write_b128 v13, v[136:139] offset:10496
    ds_write_b128 v13, v[140:143] offset:11648
    ds_read_b64_tr_b16 v[64:65], v14 offset:8192
    ds_read_b64_tr_b16 v[66:67], v14 offset:8768
    ds_read_b64_tr_b16 v[68:69], v14 offset:8224
    ds_read_b64_tr_b16 v[70:71], v14 offset:8800
    ds_read_b64_tr_b16 v[72:73], v14 offset:8256
    ds_read_b64_tr_b16 v[74:75], v14 offset:8832
    ds_read_b64_tr_b16 v[76:77], v14 offset:8288
    ds_read_b64_tr_b16 v[78:79], v14 offset:8864
    v_lshlrev_b32 v61, 16, v61
L_mlp:
    s_waitcnt vmcnt(0)
    v_xor_b32 v122, s62, v98
    v_xor_b32 v123, s63, v99
    v_or_b32 v122, v122, v123
    v_max3_u32 v11, v80, v81, v82
    v_max_u32 v11, v11, v83
    v_cmp_ne_u32 s[56:57], 0, v122
    v_cmp_eq_u32 vcc, -1, v11
    s_nop 1
    s_mov_b64 exec, vcc
    s_cbranch_execz L_mlo
    buffer_load_dwordx4 v[80:83], v16, s[36:39], s44 offen sc1
L_mlo:
    s_mov_b64 exec, s[56:57]
    s_cbranch_execz L_mld
    buffer_load_dwordx4 v[96:99], v15, s[36:39], s45 offen sc1
    s_mov_b64 exec, -1
    s_sub_u32 s50, s50, 1
    s_cbranch_scc0 L_mlp
    s_endpgm
L_mld:
    s_mov_b64 exec, -1
    v_mov_b32 v98, v96
    s_nop 1
    v_max_f32_dpp v98, v98, v98 quad_perm:[1,0,3,2] row_mask:0xf bank_mask:0xf
    s_nop 1
    v_max_f32_dpp v98, v98, v98 quad_perm:[2,3,0,1] row_mask:0xf bank_mask:0xf
    s_nop 1
    v_max_f32_dpp v98, v98, v98 row_half_mirror row_mask:0xf bank_mask:0xf
    v_sub_f32 v96, v96, v98
    v_mul_f32 v96, 0x3fb8aa3b, v96
    v_exp_f32 v96, v96
    s_nop 0
    v_mul_f32 v97, v96, v97
    s_nop 1
    v_add_f32_dpp v97, v97, v97 quad_perm:[1,0,3,2] row_mask:0xf bank_mask:0xf
    s_nop 1
    v_add_f32_dpp v97, v97, v97 quad_perm:[2,3,0,1] row_mask:0xf bank_mask:0xf
    s_nop 1
    v_add_f32_dpp v97, v97, v97 row_half_mirror row_mask:0xf bank_mask:0xf
    v_rcp_f32 v98, v97
    s_nop 0
    v_fma_f32 v99, -v97, v98, 1.0
    v_fma_f32 v98, v99, v98, v98
    v_mul_f32 v96, v96, v98
    s_nop 1
    v_mov_b32_dpp v100, v96 row_newbcast:0 row_mask:0x5 bank_mask:0xf
    v_mov_b32_dpp v101, v96 row_newbcast:1 row_mask:0x5 bank_mask:0xf
    v_mov_b32_dpp v102, v96 row_newbcast:2 row_mask:0x5 bank_mask:0xf
    v_mov_b32_dpp v103, v96 row_newbcast:3 row_mask:0x5 bank_mask:0xf
    v_mov_b32_dpp v100, v96 row_newbcast:4 row_mask:0xa bank_mask:0xf
    v_mov_b32_dpp v101, v96 row_newbcast:5 row_mask:0xa bank_mask:0xf
    v_mov_b32_dpp v102, v96 row_newbcast:6 row_mask:0xa bank_mask:0xf
    v_mov_b32_dpp v103, v96 row_newbcast:7 row_mask:0xa bank_mask:0xf
L_op:
    s_waitcnt vmcnt(0) lgkmcnt(0)
    v_mfma_f32_16x16x32_bf16 v[104:107], v[80:83], v[64:67], 0
    v_mfma_f32_16x16x32_bf16 v[108:111], v[80:83], v[68:71], 0
    v_mfma_f32_16x16x32_bf16 v[112:115], v[80:83], v[72:75], 0
    v_mfma_f32_16x16x32_bf16 v[116:119], v[80:83], v[76:79], 0
    v_max3_u32 v11, v80, v81, v82
    v_max_u32 v11, v11, v83
    v_cmp_eq_u32 vcc, -1, v11
    s_nop 1
    s_cbranch_vccz L_opd
    s_mov_b64 exec, vcc
    buffer_load_dwordx4 v[80:83], v16, s[36:39], s44 offen sc1
    s_mov_b64 exec, -1
    s_sub_u32 s50, s50, 1
    s_cbranch_scc0 L_op
    s_endpgm
L_opd:
    s_cmp_lg_u32 s83, 0
    s_cbranch_scc1 L_nfl
    s_mov_b64 exec, 0xff
    buffer_store_dwordx2 v[32:33], v19, s[36:39], s58 offen sc1
    s_mov_b64 exec, -1
L_nfl:
    v_mul_f32 v120, v100, v104
    v_mul_f32 v121, v100, v108
    v_mul_f32 v122, v100, v112
    v_mul_f32 v123, v100, v116
    v_fmac_f32 v120, v101, v105
    v_fmac_f32 v121, v101, v109
    v_fmac_f32 v122, v101, v113
    v_fmac_f32 v123, v101, v117
    v_fmac_f32 v120, v102, v106
    v_fmac_f32 v121, v102, v110
    v_fmac_f32 v122, v102, v114
    v_fmac_f32 v123, v102, v118
    v_fmac_f32 v120, v103, v107
    v_fmac_f32 v121, v103, v111
    v_fmac_f32 v122, v103, v115
    v_fmac_f32 v123, v103, v119
    v_permlane16_swap_b32 v120, v121
    s_nop 0
L_hop9:
    s_cbranch_execz L_warmret
    v_permlane16_swap_b32 v122, v123
    v_add_f32 v120, v120, v121
    v_add_f32 v122, v122, v123
    s_nop 1
    v_permlane32_swap_b32 v120, v122
    v_add_f32 v120, v120, v122
    ds_write_b32 v56, v120 offset:2560
    s_waitcnt lgkmcnt(0)
    s_barrier
    s_cmp_eq_u32 s3, 3
    s_cbranch_scc1 L_fin
    s_cmp_eq_u32 s3, 2
    s_cbranch_scc1 L_ypub
    s_endpgm
L_ypub:
    ds_read_b64 v[20:21], v18 offset:2560
    s_mov_b32 exec_lo, 0x55555555
    s_mov_b32 exec_hi, 0x55555555
    ds_read_b64 v[22:23], v58 offset:2816
    ds_read_b64 v[24:25], v58 offset:3072
    ds_read_b64 v[26:27], v58 offset:3328
    s_mov_b64 exec, -1
    s_waitcnt lgkmcnt(2)
    v_add_f32 v30, v20, v22
    v_add_f32 v31, v21, v23
    s_waitcnt lgkmcnt(0)
    v_add_f32 v24, v24, v26
    v_add_f32 v25, v25, v27
    v_add_f32 v30, v30, v24
    v_add_f32 v31, v31, v25
    buffer_store_dwordx4 v[30:33], v59, s[36:39], s55 offen sc1
    s_endpgm
L_fin:
    s_mov_b32 exec_hi, 0
L_fp:
    buffer_load_dwordx2 v[30:31], v28, s[36:39], s59 offen sc1
    s_waitcnt vmcnt(0)
    v_xor_b32 v30, s62, v30
    v_xor_b32 v31, s63, v31
    v_or_b32 v30, v30, v31
    v_cmp_ne_u32 vcc, 0, v30
    s_nop 1
    s_cbranch_vccz L_fpd
    s_mov_b64 exec, vcc
    s_sub_u32 s50, s50, 1
    s_cbranch_scc0 L_fp
    s_endpgm
L_fpd:
    s_mov_b64 exec, -1
L_yp:
    buffer_load_dwordx4 v[124:127], v57, s[36:39], s54 offen sc1
    s_waitcnt vmcnt(0)
    v_xor_b32 v10, s62, v126
    v_xor_b32 v11, s63, v127
    v_or_b32 v10, v10, v11
    v_cmp_ne_u32 vcc, 0, v10
    s_nop 1
    s_cbranch_vccz L_ypd
    s_mov_b64 exec, vcc
    s_sub_u32 s50, s50, 1
    s_cbranch_scc0 L_yp
    s_endpgm
L_ypd:
    s_mov_b64 exec, -1
    v_permlane16_swap_b32 v124, v125
    v_add_f32 v124, v124, v125
    v_mov_b32 v125, v124
    s_nop 1
    v_permlane32_swap_b32 v124, v125
    v_add_f32 v124, v124, v125
    s_nop 1
    v_add_f32_dpp v124, v124, v124 row_ror:8 row_mask:0xf bank_mask:0xf
    s_nop 1
    v_add_f32_dpp v124, v124, v124 row_ror:4 row_mask:0xf bank_mask:0xf
    s_nop 1
    v_add_f32_dpp v124, v124, v124 row_ror:2 row_mask:0xf bank_mask:0xf
    v_cvt_pk_bf16_f32 v124, v124, v124
    v_and_b32 v124, 0xffff0000, v124
    v_add_f32 v124, v124, v61
    v_cvt_pk_bf16_f32 v124, v124, v124
    v_and_b32 v124, 0xffff0000, v124
    s_nop 1
    v_add_f32_dpp v124, v124, v124 quad_perm:[1,0,3,2] row_mask:0xf bank_mask:0xf
    v_cvt_pk_bf16_f32 v124, v124, v124
    s_mov_b64 exec, 0x10001
    global_store_short v60, v124, s[28:29]
    s_cmp_lg_u32 s2, 0
    s_cbranch_scc1 L_noep
    s_mov_b32 s48, 819200
    s_mov_b64 exec, 1
    buffer_store_dwordx2 v[32:33], v2, s[36:39], s48 offen
L_noep:
L_end:
    s_endpgm
.section .rodata,"a"
.p2align 6
.amdhsa_kernel parallel_sum__sliding_block_cached__mixer_channel_mlp__decode_kernel
  .amdhsa_next_free_vgpr 168
  .amdhsa_next_free_sgpr 96
  .amdhsa_accum_offset 168
  .amdhsa_group_segment_fixed_size 0
  .amdhsa_kernarg_size 104
  .amdhsa_user_sgpr_count 2
  .amdhsa_user_sgpr_kernarg_segment_ptr 1
  .amdhsa_system_sgpr_workgroup_id_x 1
.end_amdhsa_kernel
```
